```python
import torch

def _softmax(x, axis=-1):
    return torch.softmax(x, dim=axis)

def _gelu(x):
    return torch.nn.functional.gelu(x, approximate='tanh')

def _silu(x):
    return torch.nn.functional.silu(x)

def _sigmoid(x):
    return torch.sigmoid(x)

def _layernorm(x, axis=-1, eps=1e-05):
    m = x.mean(dim=axis, keepdim=True)
    v = x.var(dim=axis, keepdim=True, unbiased=False)
    return (x - m) / torch.sqrt(v + eps)

def _scatter_add(tgt, idx, src, axis=0):
    return tgt.clone().index_add_(axis, idx, src)

def _segment_sum(src, seg, n):
    out = torch.zeros((n,) + src.shape[1:], dtype=src.dtype)
    return out.index_add_(0, seg, src)

def _pad(x, pw):
    flat = tuple((v for pair in reversed(pw) for v in pair))
    return torch.nn.functional.pad(x, flat)
kernel_name = 'adaLN_cond__gqa_block_cached__swiglu_ffn__decode'

def setup_inputs():

    _w = lambda a: (lambda t: t.to(torch.bfloat16) if t.is_floating_point() else t)(torch.as_tensor(a))

    def _A_setup():
        B, Sq, D = (1, 1, 512)
        Hq, Hkv, Sk, Dh = (32, 8, 65536, 128)
        assert Hq % Hkv == 0, (Hq, Hkv)
        return {'x': _w((lambda *s: torch.randn(*s, dtype=torch.bfloat16) * 0.05)(B, Sq, D)), 'k_cache': _w((lambda *s: torch.randn(*s, dtype=torch.bfloat16) * 3.2)(B, Hkv, Sk, Dh)), 'v_cache': _w((lambda *s: torch.randn(*s, dtype=torch.bfloat16) * 0.4)(B, Hkv, Sk, Dh)), 'wq': _w((lambda *s: torch.randn(*s, dtype=torch.bfloat16) * 3.2)(D, Hq * Dh) * D ** (-0.5)), 'wo': _w((lambda *s: torch.randn(*s, dtype=torch.bfloat16) * 0.4)(Hq * Dh, D) * (Hq * Dh) ** (-0.5))}
    _A_in = _A_setup()

    def _B_setup():
        B, S, D, F = (1, 1, 512, 1792)
        return {'x': _w((lambda *s: torch.randn(*s, dtype=torch.bfloat16) * 0.05)(B, S, D)), 'w_gate': _w((lambda *s: torch.randn(*s, dtype=torch.bfloat16) * 0.05)(D, F)), 'w_up': _w((lambda *s: torch.randn(*s, dtype=torch.bfloat16) * 0.05)(D, F)), 'w_down': _w((lambda *s: torch.randn(*s, dtype=torch.bfloat16) * 0.05)(F, D))}
    _B_in = _B_setup()
    return {'A_x': _A_in['x'], 'A_k_cache': _A_in['k_cache'], 'A_v_cache': _A_in['v_cache'], 'A_wq': _A_in['wq'], 'A_wo': _A_in['wo'], 'B_x': _B_in['x'], 'B_w_gate': _B_in['w_gate'], 'B_w_up': _B_in['w_up'], 'B_w_down': _B_in['w_down'], 'c': _w((lambda *s: torch.randn(*s, dtype=torch.bfloat16) * 0.2)(1, 512) * 8.0), 'w_mod': _w((lambda *s: torch.randn(*s, dtype=torch.bfloat16) * 0.2)(512, 6 * 512) * 512 ** (-0.5) * 8.0)}

def reference(A_x, A_k_cache, A_v_cache, A_wq, A_wo, B_x, B_w_gate, B_w_up, B_w_down, c, w_mod):

    def _A_ref(x, k_cache, v_cache, wq, wo):
        B, Sq, D = x.shape
        Hq, Dh = (32, 128)
        Hkv = k_cache.shape[1]
        rep = Hq // Hkv
        q = (lambda x, *d: x.permute(*d))((x @ wq).reshape(B, Sq, Hq, Dh), 0, 2, 1, 3)
        k = (lambda x, n, axis: torch.repeat_interleave(x, n, dim=axis))(k_cache, rep, axis=1)
        v = (lambda x, n, axis: torch.repeat_interleave(x, n, dim=axis))(v_cache, rep, axis=1)
        scores = torch.einsum('bhqd,bhkd->bhqk', q, k) * Dh ** (-0.5)
        p = _softmax(scores, axis=-1)
        o = torch.einsum('bhqk,bhkd->bhqd', p, v)
        return (lambda x, *d: x.permute(*d))(o, 0, 2, 1, 3).reshape(B, Sq, Hq * Dh) @ wo

    def _B_ref(x, w_gate, w_up, w_down):
        g = _silu(x @ w_gate)
        u = x @ w_up
        return g * u @ w_down
    x = A_x
    mod = (_silu(c) @ w_mod).reshape(c.shape[0], 6, 1, -1)
    sa, ca, ga, sb, cb, gb = (mod[:, 0].clone(), mod[:, 1].clone(), mod[:, 2].clone(), mod[:, 3].clone(), mod[:, 4].clone(), mod[:, 5].clone())
    h = _layernorm(x, axis=-1) * (1 + ca) + sa
    x = x + ga * _A_ref(h, A_k_cache, A_v_cache, A_wq, A_wo)
    h = _layernorm(x, axis=-1) * (1 + cb) + sb
    x = x + gb * _B_ref(h, B_w_gate, B_w_up, B_w_down)
    return x
```

```asm
; @launch grid=(256,1,1) block=(512,1,1) lds=160768
.amdgcn_target "amdgcn-amd-amdhsa--gfx950"
.text
.globl adaLN_cond__gqa_block_cached__swiglu_ffn__decode_kernel
.p2align 8
.type adaLN_cond__gqa_block_cached__swiglu_ffn__decode_kernel,@function
adaLN_cond__gqa_block_cached__swiglu_ffn__decode_kernel:
  s_cmp_ge_u32 s2, 256
  s_cbranch_scc1 L_exit
  s_load_dwordx16 s[4:19], s[0:1], 0
  s_load_dwordx8 s[20:27], s[0:1], 64
  s_load_dwordx4 s[28:31], s[0:1], 96
  v_lshrrev_b32 v1, 6, v0
  v_and_b32 v0, 63, v0
  v_readfirstlane_b32 s3, v1
  v_lshlrev_b32 v2, 4, v0
  s_lshr_b32 s58, s2, 5
  s_and_b32 s59, s2, 24
  s_sub_u32 s54, s58, s2
  s_and_b32 s54, s54, 7
  s_lshl_b32 s54, s54, 2
  s_lshr_b32 s59, s59, 3
  s_add_u32 s54, s54, s59
  s_and_b32 s59, s54, 24
  v_and_b32 v3, 12, v0
  v_lshrrev_b32 v8, 4, v0
  v_add_lshl_u32 v3, v3, v8, 6
  v_and_b32 v4, 3, v0
  v_lshl_add_u32 v1, v4, 4, v3
  s_cmp_lt_u32 s3, 4
  s_cbranch_scc1 L_stream
  s_sub_u32 s52, s3, 4
  s_and_b32 s53, s2, 7
  s_cmp_eq_u32 s59, 8
  s_cbranch_scc0 L_nowarm
  s_getpc_b64 s[44:45]
L_pc:
  s_sub_u32 s44, s44, L_pc-adaLN_cond__gqa_block_cached__swiglu_ffn__decode_kernel
  s_subb_u32 s45, s45, 0
  s_mov_b32 s46, L_codeend-adaLN_cond__gqa_block_cached__swiglu_ffn__decode_kernel
  s_mov_b32 s47, 0x20000
  s_lshl_b32 s58, s52, 10
  buffer_load_dwordx4 v[12:15], v2, s[44:47], s58 offen
  s_add_u32 s58, s58, 4096
  buffer_load_dwordx4 v[12:15], v2, s[44:47], s58 offen
  s_add_u32 s58, s58, 4096
  buffer_load_dwordx4 v[12:15], v2, s[44:47], s58 offen
  s_add_u32 s58, s58, 4096
  buffer_load_dwordx4 v[12:15], v2, s[44:47], s58 offen
  s_add_u32 s58, s58, 4096
  buffer_load_dwordx4 v[12:15], v2, s[44:47], s58 offen
  s_add_u32 s58, s58, 4096
  buffer_load_dwordx4 v[12:15], v2, s[44:47], s58 offen
L_nowarm:
  s_setprio 3
  s_lshl_b32 s56, s52, 14
  v_and_b32 v10, 7, v0
  v_and_b32 v11, 16, v0
  v_lshrrev_b32 v11, 3, v11
  v_xor_b32 v10, v10, v11
  v_lshlrev_b32 v62, 4, v10
  s_lshr_b32 s58, 0xff0000ff, s54
  s_and_b32 s58, s58, 1
  s_cbranch_scc0 L_chain2
  s_and_b32 s58, s54, 7
  s_lshl_b32 s64, s53, 3
  s_add_u32 s58, s58, s64
  s_and_b32 s67, s58, 3
  s_lshl_b32 s64, s67, 2
  s_add_u32 s64, s64, s52
  s_lshl_b32 s66, s52, 2
  s_lshr_b32 s63, s58, 2
  s_lshl_b32 s62, s52, 12
  s_add_u32 s62, s62, 91136
  s_cmp_lt_u32 s54, 8
  s_cselect_b32 s64, s66, s64
  s_cselect_b32 s58, s58, s63
  s_cselect_b32 m0, s56, s62
  s_cselect_b32 s65, 4, 3
  s_cselect_b32 s66, 4, 1
  s_lshl_b32 s65, s65, 11
  s_lshl_b32 s66, s66, 12
  s_add_u32 s66, s66, m0
  v_lshrrev_b32 v4, 3, v0
  v_mul_lo_u32 v4, v4, s65
  v_xor_b32 v3, 64, v62
  v_add_u32 v3, v3, v4
  v_add_u32 v4, v4, v62
  s_mul_i32 s64, s64, s65
  s_lshl_b32 s64, s64, 5
  s_lshl_b32 s63, s58, 7
  s_add_u32 s64, s64, s63
  s_lshl_b32 s46, s65, 9
  s_mov_b32 s47, 0x20000
  s_mov_b32 s50, 1024
  s_mov_b32 s51, 0x20000
  s_lshl_b32 s65, s65, 3
  s_cmp_lt_u32 s54, 8
  s_waitcnt lgkmcnt(0)
  s_cselect_b64 s[44:45], s[10:11], s[24:25]
  s_cselect_b64 s[48:49], s[4:5], s[22:23]
  buffer_load_dwordx4 v[16:19], v2, s[48:51], 0 offen
L_dma:
  buffer_load_dwordx4 v4, s[44:47], s64 offen lds
  s_add_u32 m0, m0, 1024
  s_add_u32 s64, s64, s65
  buffer_load_dwordx4 v3, s[44:47], s64 offen lds
  s_add_u32 m0, m0, 1024
  s_add_u32 s64, s64, s65
  s_cmp_lt_u32 m0, s66
  s_cbranch_scc1 L_dma
  s_branch L_chain2
L_stream:
  s_mov_b32 s72, 4
  s_cmp_ge_u32 s54, 8
  s_cselect_b32 s72, 0, s72
  s_cmp_ge_u32 s54, 16
  s_cselect_b32 s72, 1, s72
  s_cmp_ge_u32 s54, 23
  s_cselect_b32 s72, 1, s72
  s_cmp_ge_u32 s54, 24
  s_cselect_b32 s72, 3, s72
  s_cmp_ge_u32 s54, 28
  s_cselect_b32 s72, 3, s72
  s_lshl_b32 s58, s58, 3
  s_lshr_b32 s59, s54, 2
  s_add_u32 s58, s58, s59
  s_lshl_b32 s58, s58, 7
  s_and_b32 s59, s54, 3
  s_add_u32 s58, s58, s59
  s_lshl_b32 s58, s58, 2
  s_add_u32 s58, s58, s3
  s_lshl_b32 s58, s58, 12
  s_add_u32 s55, s58, 2031616
  s_lshl_b32 s59, s72, 16
  s_add_u32 s64, s58, s59
  s_add_u32 s52, s64, s59
  s_lshl_b32 s61, 1, s54
  s_mov_b32 s34, 0x8000000
  s_mov_b32 s35, 0x20000
  s_mov_b32 s38, 0x8000000
  s_mov_b32 s39, 0x20000
  s_and_b32 s58, s61, 0xff0000ff
  s_cbranch_scc0 L_nh1
  s_barrier
  s_barrier
L_nh1:
  s_waitcnt lgkmcnt(0)
  s_mov_b64 s[32:33], s[6:7]
  s_mov_b64 s[36:37], s[8:9]
  s_mov_b32 s74, s52
  s_mov_b32 s53, s52
  buffer_load_dwordx4 v[64:67], v1, s[32:35], s53 offen offset:0 nt
  buffer_load_dwordx4 v[68:71], v1, s[32:35], s53 offen offset:1024 nt
  buffer_load_dwordx4 v[72:75], v1, s[32:35], s53 offen offset:2048 nt
  buffer_load_dwordx4 v[76:79], v1, s[32:35], s53 offen offset:3072 nt
  s_add_u32 s52, s52, 65536
  s_mov_b32 s53, s52
  buffer_load_dwordx4 v[80:83], v1, s[32:35], s53 offen offset:0 nt
  buffer_load_dwordx4 v[84:87], v1, s[32:35], s53 offen offset:1024 nt
  buffer_load_dwordx4 v[88:91], v1, s[32:35], s53 offen offset:2048 nt
  buffer_load_dwordx4 v[92:95], v1, s[32:35], s53 offen offset:3072 nt
  s_add_u32 s52, s52, 65536
  s_mov_b32 s53, s52
  s_waitcnt vmcnt(4)
  buffer_load_dwordx4 v[96:99], v1, s[32:35], s53 offen offset:0 nt
  buffer_load_dwordx4 v[100:103], v1, s[32:35], s53 offen offset:1024 nt
  buffer_load_dwordx4 v[104:107], v1, s[32:35], s53 offen offset:2048 nt
  buffer_load_dwordx4 v[108:111], v1, s[32:35], s53 offen offset:3072 nt
  s_add_u32 s52, s52, 65536
  s_mov_b32 s53, s52
  s_waitcnt vmcnt(4)
  buffer_load_dwordx4 v[112:115], v1, s[32:35], s53 offen offset:0 nt
  buffer_load_dwordx4 v[116:119], v1, s[32:35], s53 offen offset:1024 nt
  buffer_load_dwordx4 v[120:123], v1, s[32:35], s53 offen offset:2048 nt
  buffer_load_dwordx4 v[124:127], v1, s[32:35], s53 offen offset:3072 nt
  s_add_u32 s52, s52, 65536
  s_mov_b32 s53, s52
  s_waitcnt vmcnt(4)
  buffer_load_dwordx4 v[128:131], v1, s[32:35], s53 offen offset:0 nt
  buffer_load_dwordx4 v[132:135], v1, s[32:35], s53 offen offset:1024 nt
  buffer_load_dwordx4 v[136:139], v1, s[32:35], s53 offen offset:2048 nt
  buffer_load_dwordx4 v[140:143], v1, s[32:35], s53 offen offset:3072 nt
  s_add_u32 s52, s52, 65536
  s_mov_b32 s53, s52
  s_waitcnt vmcnt(4)
  buffer_load_dwordx4 v[144:147], v1, s[32:35], s53 offen offset:0 nt
  buffer_load_dwordx4 v[148:151], v1, s[32:35], s53 offen offset:1024 nt
  buffer_load_dwordx4 v[152:155], v1, s[32:35], s53 offen offset:2048 nt
  buffer_load_dwordx4 v[156:159], v1, s[32:35], s53 offen offset:3072 nt
  s_add_u32 s52, s52, 65536
  s_and_b32 s58, s61, 0xffff00
  s_cbranch_scc0 L_cb2
  s_barrier
L_cb2:
  s_mov_b32 s53, s52
  s_waitcnt vmcnt(4)
  buffer_load_dwordx4 v[160:163], v1, s[32:35], s53 offen offset:0 nt
  buffer_load_dwordx4 v[164:167], v1, s[32:35], s53 offen offset:1024 nt
  buffer_load_dwordx4 v[168:171], v1, s[32:35], s53 offen offset:2048 nt
  buffer_load_dwordx4 v[172:175], v1, s[32:35], s53 offen offset:3072 nt
  s_add_u32 s52, s52, 65536
  s_mov_b32 s53, s52
  s_waitcnt vmcnt(4)
  buffer_load_dwordx4 v[176:179], v1, s[32:35], s53 offen offset:0 nt
  buffer_load_dwordx4 v[180:183], v1, s[32:35], s53 offen offset:1024 nt
  buffer_load_dwordx4 v[184:187], v1, s[32:35], s53 offen offset:2048 nt
  buffer_load_dwordx4 v[188:191], v1, s[32:35], s53 offen offset:3072 nt
  s_add_u32 s52, s52, 65536
  s_mov_b32 s53, s52
  s_waitcnt vmcnt(4)
  buffer_load_dwordx4 v[192:195], v1, s[32:35], s53 offen offset:0 nt
  buffer_load_dwordx4 v[196:199], v1, s[32:35], s53 offen offset:1024 nt
  buffer_load_dwordx4 v[200:203], v1, s[32:35], s53 offen offset:2048 nt
  buffer_load_dwordx4 v[204:207], v1, s[32:35], s53 offen offset:3072 nt
  s_add_u32 s52, s52, 65536
  s_mov_b32 s53, s52
  s_waitcnt vmcnt(4)
  buffer_load_dwordx4 v[208:211], v1, s[32:35], s53 offen offset:0 nt
  buffer_load_dwordx4 v[212:215], v1, s[32:35], s53 offen offset:1024 nt
  buffer_load_dwordx4 v[216:219], v1, s[32:35], s53 offen offset:2048 nt
  buffer_load_dwordx4 v[220:223], v1, s[32:35], s53 offen offset:3072 nt
  s_add_u32 s52, s52, 65536
  s_and_b32 s58, s61, 0xff
  s_cbranch_scc0 L_mk3
  v_mov_b32 v52, 90112
  v_mov_b32 v53, 1
  s_mov_b64 exec, 1
  ds_add_u32 v52, v53 offset:16
  s_mov_b64 exec, -1
L_mk3:
  s_mov_b32 s53, s52
  s_waitcnt vmcnt(4)
  buffer_load_dwordx4 v[224:227], v1, s[32:35], s53 offen offset:0 nt
  buffer_load_dwordx4 v[228:231], v1, s[32:35], s53 offen offset:1024 nt
  buffer_load_dwordx4 v[232:235], v1, s[32:35], s53 offen offset:2048 nt
  buffer_load_dwordx4 v[236:239], v1, s[32:35], s53 offen offset:3072 nt
  s_add_u32 s52, s52, 65536
  s_mov_b32 s53, s52
  s_waitcnt vmcnt(4)
  buffer_load_dwordx4 v[240:243], v1, s[32:35], s53 offen offset:0 nt
  buffer_load_dwordx4 v[244:247], v1, s[32:35], s53 offen offset:1024 nt
  buffer_load_dwordx4 v[248:251], v1, s[32:35], s53 offen offset:2048 nt
  buffer_load_dwordx4 v[252:255], v1, s[32:35], s53 offen offset:3072 nt
  s_add_u32 s52, s52, 65536
  s_and_b32 s58, s61, 0xffffff00
  s_cbranch_scc0 L_mk4
  v_mov_b32 v52, 90112
  v_mov_b32 v53, 1
  s_mov_b64 exec, 1
  ds_add_u32 v52, v53 offset:16
  s_mov_b64 exec, -1
L_mk4:
  s_mov_b32 s53, s52
  s_waitcnt vmcnt(4)
  s_lshl_b32 s58, s3, 12
  s_add_u32 m0, s58, 91136
  s_nop 0
  buffer_load_dwordx4 v1, s[32:35], s53 offen offset:0 nt lds
  buffer_load_dwordx4 v1, s[32:35], s53 offen offset:1024 nt lds
  buffer_load_dwordx4 v1, s[32:35], s53 offen offset:2048 nt lds
  buffer_load_dwordx4 v1, s[32:35], s53 offen offset:3072 nt lds
  s_add_u32 s52, s52, 65536
  s_mov_b32 s53, s52
  s_waitcnt vmcnt(4)
  s_lshl_b32 s58, s3, 12
  s_add_u32 m0, s58, 144384
  s_nop 0
  buffer_load_dwordx4 v1, s[32:35], s53 offen offset:0 nt lds
  buffer_load_dwordx4 v1, s[32:35], s53 offen offset:1024 nt lds
  buffer_load_dwordx4 v1, s[32:35], s53 offen offset:2048 nt lds
  buffer_load_dwordx4 v1, s[32:35], s53 offen offset:3072 nt lds
  s_add_u32 s52, s52, 65536
  s_mov_b32 s40, s30
  s_mov_b32 s41, s31
  s_mov_b32 s42, 0x200000
  s_mov_b32 s43, 0x20000
  s_mov_b32 s56, 0x3db504f3
  s_mov_b32 s57, 0x3fb8aa3b
  v_mov_b32 v8, 0
  v_mov_b32 v9, 0
  v_mov_b32 v10, 0
  v_mov_b32 v11, 0
  v_mov_b32 v12, 0
  v_mov_b32 v13, 0
  v_mov_b32 v14, 0
  v_mov_b32 v15, 0
  v_mov_b32 v16, 0xff7fffff
  v_mov_b32 v18, 0
  v_and_b32 v20, 3, v0
  v_cmp_eq_u32 vcc, 0, v20
  s_nop 1
  v_cndmask_b32 v24, 0, 1.0, vcc
  v_cmp_eq_u32 vcc, 1, v20
  s_nop 1
  v_cndmask_b32 v25, 0, 1.0, vcc
  v_cmp_eq_u32 vcc, 2, v20
  s_nop 1
  v_cndmask_b32 v26, 0, 1.0, vcc
  v_cmp_eq_u32 vcc, 3, v20
  s_nop 1
  v_cndmask_b32 v27, 0, 1.0, vcc
  v_and_b32 v21, 1, v0
  v_lshlrev_b32 v21, 4, v21
  v_mov_b32 v19, 0xffff
  v_lshlrev_b32 v21, v21, v19
  v_cmp_gt_u32 vcc, 2, v20
  s_nop 1
  v_cndmask_b32 v22, 0, v21, vcc
  v_cndmask_b32 v23, v21, 0, vcc
  v_add_u32 v3, 69632, v2
  s_mul_i32 s58, s3, 2560
  s_add_u32 s58, s58, 71680
  v_and_b32 v56, 12, v0
  v_lshrrev_b32 v57, 4, v0
  v_add_lshl_u32 v56, v56, v57, 7
  v_lshl_add_u32 v56, v20, 4, v56
  v_add_u32 v56, s58, v56
  v_lshlrev_b32 v59, 3, v0
  v_add_u32 v57, s58, v59
  s_lshl_b32 s58, s3, 10
  s_add_u32 s59, s58, 71680
  v_add_u32 v58, s59, v2
  s_lshl_b32 s67, s2, 11
  s_add_u32 s67, s67, s58
  s_add_u32 s67, s67, 262144
  s_cmp_lt_u32 s3, 2
  s_cbranch_scc1 L_e0a
  s_lshl_b32 s67, s2, 7
  s_add_u32 s67, s67, 786432
  v_mov_b32 v58, v59
  v_add_u32 v59, 73728, v59
  s_branch L_e0b
L_e0a:
  v_and_b32 v59, 32, v0
  s_lshl_b32 s58, s3, 6
  s_add_u32 s58, s58, 73728
  v_add_u32 v59, s58, v59
L_e0b:
  s_lshr_b32 s58, s2, 5
  s_lshl_b32 s58, s58, 10
  v_mov_b32 v54, 0x0
  v_mov_b32 v21, 0x6c
  v_cmp_le_u32 vcc, 16, v0
  s_nop 1
  v_cndmask_b32 v54, v54, v21, vcc
  v_mov_b32 v21, 0xd8
  v_cmp_le_u32 vcc, 36, v0
  s_nop 1
  v_cndmask_b32 v54, v54, v21, vcc
  v_mov_b32 v21, 0x154
  v_cmp_le_u32 vcc, 40, v0
  s_nop 1
  v_cndmask_b32 v54, v54, v21, vcc
  v_mov_b32 v21, 0x1d0
  v_cmp_le_u32 vcc, 44, v0
  s_nop 1
  v_cndmask_b32 v54, v54, v21, vcc
  v_mov_b32 v21, 0x248
  v_cmp_le_u32 vcc, 52, v0
  s_nop 1
  v_cndmask_b32 v54, v54, v21, vcc
  v_mov_b32 v21, 0x2c0
  v_cmp_le_u32 vcc, 60, v0
  s_nop 1
  v_cndmask_b32 v54, v54, v21, vcc
  v_lshl_add_u32 v54, v0, 0, v54
  v_add_lshl_u32 v54, v54, s58, 14
  v_mov_b32 v55, 0x300
  v_mov_b32 v21, 0x370
  v_cmp_le_u32 vcc, 12, v0
  s_nop 1
  v_cndmask_b32 v55, v55, v21, vcc
  v_mov_b32 v21, 0x3e0
  v_cmp_le_u32 vcc, 28, v0
  s_nop 1
  v_cndmask_b32 v55, v55, v21, vcc
  v_lshl_add_u32 v55, v0, 0, v55
  v_add_lshl_u32 v55, v55, s58, 14
  s_barrier
  ds_read_b128 v[4:7], v3
  s_waitcnt lgkmcnt(0)
  s_branch L_stream2
L_chain2:
  s_waitcnt lgkmcnt(0)
  s_load_dword s55, s[30:31], 0
  s_memrealtime s[100:101]
  s_lshl_b32 s57, s52, 10
  s_add_u32 s57, s57, 65536
  v_and_b32 v9, 15, v0
  v_mov_b32 v238, 0
  v_lshlrev_b32 v10, 2, v9
  v_add_u32 v10, 90112, v10
  ds_write_b32 v10, v238
  v_lshrrev_b32 v10, 2, v9
  v_lshl_add_u32 v10, v8, 3, v10
  v_lshlrev_b32 v5, 7, v10
  v_and_b32 v10, 24, v0
  v_lshl_add_u32 v5, v10, 2, v5
  v_and_b32 v10, 3, v0
  v_lshl_add_u32 v5, v10, 3, v5
  v_lshlrev_b32 v6, 4, v8
  v_add_u32 v6, s57, v6
  v_add_u32 v7, s57, v2
  s_mov_b32 s40, s30
  s_mov_b32 s41, s31
  s_mov_b32 s42, 0x200000
  s_mov_b32 s43, 0x20000
  s_lshl_b32 s58, s58, 2
  s_add_u32 s58, s58, s52
  s_lshl_b32 s59, s52, 5
  v_xor_b32 v61, s59, v5
  s_waitcnt lgkmcnt(0)
  s_add_u32 s55, s55, 1
  v_mov_b32 v13, s55
  v_mov_b32 v15, s55
  s_cmp_lt_u32 s54, 8
  s_cbranch_scc1 L_p2
  s_cmp_lt_u32 s54, 24
  s_cbranch_scc1 L_bx
  s_lshl_b32 s64, s58, 7
  s_lshl_b32 s59, s67, 13
  s_add_u32 s64, s64, s59
  s_add_u32 s64, s64, 65536
  s_lshl_b32 s59, s67, 8
  v_add_u32 v60, s59, v6
  v_add_u32 v59, 91136, v61
  v_lshlrev_b32 v58, 5, v8
  v_lshl_add_u32 v58, v9, 4, v58
  s_waitcnt vmcnt(4)
  v_lshlrev_b32 v24, 16, v16
  v_and_b32 v25, 0xffff0000, v16
  v_lshlrev_b32 v26, 16, v17
  v_and_b32 v27, 0xffff0000, v17
  v_lshlrev_b32 v28, 16, v18
  v_and_b32 v29, 0xffff0000, v18
  v_lshlrev_b32 v30, 16, v19
  v_and_b32 v31, 0xffff0000, v19
  s_mov_b32 s59, 0xbfb8aa3b
  v_mul_f32 v32, s59, v24
  v_mul_f32 v33, s59, v25
  v_mul_f32 v34, s59, v26
  v_mul_f32 v35, s59, v27
  v_mul_f32 v36, s59, v28
  v_mul_f32 v37, s59, v29
  v_mul_f32 v38, s59, v30
  v_mul_f32 v39, s59, v31
  v_exp_f32 v32, v32
  v_exp_f32 v33, v33
  v_exp_f32 v34, v34
  v_exp_f32 v35, v35
  v_exp_f32 v36, v36
  v_exp_f32 v37, v37
  v_exp_f32 v38, v38
  v_exp_f32 v39, v39
  v_add_f32 v32, 1.0, v32
  v_add_f32 v33, 1.0, v33
  v_add_f32 v34, 1.0, v34
  v_add_f32 v35, 1.0, v35
  v_add_f32 v36, 1.0, v36
  v_add_f32 v37, 1.0, v37
  v_add_f32 v38, 1.0, v38
  v_add_f32 v39, 1.0, v39
  v_rcp_f32 v32, v32
  v_rcp_f32 v33, v33
  v_rcp_f32 v34, v34
  v_rcp_f32 v35, v35
  v_rcp_f32 v36, v36
  v_rcp_f32 v37, v37
  v_rcp_f32 v38, v38
  v_rcp_f32 v39, v39
  v_mul_f32 v24, v24, v32
  v_mul_f32 v25, v25, v33
  v_mul_f32 v26, v26, v34
  v_mul_f32 v27, v27, v35
  v_mul_f32 v28, v28, v36
  v_mul_f32 v29, v29, v37
  v_mul_f32 v30, v30, v38
  v_mul_f32 v31, v31, v39
  v_cvt_pk_bf16_f32 v16, v24, v25
  v_cvt_pk_bf16_f32 v17, v26, v27
  v_cvt_pk_bf16_f32 v18, v28, v29
  v_cvt_pk_bf16_f32 v19, v30, v31
  ds_write_b128 v7, v[16:19]
  ds_read_b128 v[160:163], v60 offset:0
  ds_read_b128 v[164:167], v60 offset:64
  ds_read_b128 v[168:171], v60 offset:128
  ds_read_b128 v[172:175], v60 offset:192
  v_cmp_eq_u32 vcc, 1, v9
  s_waitcnt vmcnt(0) lgkmcnt(0)
  s_barrier
  ds_read_b64_tr_b16 v[64:65], v59 offset:0
  ds_read_b64_tr_b16 v[66:67], v59 offset:512
  ds_read_b64_tr_b16 v[68:69], v59 offset:4096
  ds_read_b64_tr_b16 v[70:71], v59 offset:4608
  ds_read_b64_tr_b16 v[72:73], v59 offset:8192
  ds_read_b64_tr_b16 v[74:75], v59 offset:8704
  ds_read_b64_tr_b16 v[76:77], v59 offset:12288
  ds_read_b64_tr_b16 v[78:79], v59 offset:12800
  s_waitcnt lgkmcnt(6)
  v_mfma_f32_16x16x32_bf16 v[16:19], v[64:67], v[160:163], 0
  s_waitcnt lgkmcnt(4)
  v_mfma_f32_16x16x32_bf16 v[16:19], v[68:71], v[164:167], v[16:19]
  s_waitcnt lgkmcnt(2)
  v_mfma_f32_16x16x32_bf16 v[16:19], v[72:75], v[168:171], v[16:19]
  s_waitcnt lgkmcnt(0)
  v_mfma_f32_16x16x32_bf16 v[16:19], v[76:79], v[172:175], v[16:19]
  s_nop 7
  v_cndmask_b32 v12, v16, v18, vcc
  v_cndmask_b32 v14, v17, v19, vcc
  s_mov_b32 exec_lo, 0x00030003
  s_mov_b32 exec_hi, 0x00030003
  buffer_store_dwordx4 v[12:15], v58, s[40:43], s64 offen sc1
  s_mov_b64 exec, -1
  s_cmp_lt_u32 s54, 28
  s_cbranch_scc1 L_clr
  s_barrier
  s_branch L_qg
L_pn:
  s_lshl_b32 s58, s53, 2
  s_add_u32 s58, s58, s54
  s_sub_u32 s58, s58, 12
  s_mul_i32 s64, s52, 786432
  s_lshl_b32 s65, s58, 7
  s_add_u32 s64, s64, s65
  s_mov_b32 s44, s24
  s_mov_b32 s45, s25
  s_mov_b32 s46, 0x300000
  s_mov_b32 s47, 0x20000
  v_lshrrev_b32 v31, 3, v0
  s_mov_b32 s59, 6144
  v_mul_lo_u32 v31, v31, s59
  v_xor_b32 v30, 64, v62
  v_add_u32 v30, v30, v31
  v_add_u32 v31, v31, v62
  s_add_u32 m0, s56, 0
  s_add_u32 s59, s64, 0
  buffer_load_dwordx4 v31, s[44:47], s59 offen lds
  s_add_u32 m0, s56, 1024
  s_add_u32 s59, s64, 49152
  buffer_load_dwordx4 v30, s[44:47], s59 offen lds
  s_add_u32 m0, s56, 2048
  s_add_u32 s59, s64, 98304
  buffer_load_dwordx4 v31, s[44:47], s59 offen lds
  s_add_u32 m0, s56, 3072
  s_add_u32 s59, s64, 147456
  buffer_load_dwordx4 v30, s[44:47], s59 offen lds
  s_add_u32 m0, s56, 4096
  s_add_u32 s59, s64, 196608
  buffer_load_dwordx4 v31, s[44:47], s59 offen lds
  s_add_u32 m0, s56, 5120
  s_add_u32 s59, s64, 245760
  buffer_load_dwordx4 v30, s[44:47], s59 offen lds
  s_add_u32 m0, s56, 6144
  s_add_u32 s59, s64, 294912
  buffer_load_dwordx4 v31, s[44:47], s59 offen lds
  s_add_u32 m0, s56, 7168
  s_add_u32 s59, s64, 344064
  buffer_load_dwordx4 v30, s[44:47], s59 offen lds
  s_add_u32 m0, s56, 8192
  s_add_u32 s59, s64, 393216
  buffer_load_dwordx4 v31, s[44:47], s59 offen lds
  s_add_u32 m0, s56, 9216
  s_add_u32 s59, s64, 442368
  buffer_load_dwordx4 v30, s[44:47], s59 offen lds
  s_add_u32 m0, s56, 10240
  s_add_u32 s59, s64, 491520
  buffer_load_dwordx4 v31, s[44:47], s59 offen lds
  s_add_u32 m0, s56, 11264
  s_add_u32 s59, s64, 540672
  buffer_load_dwordx4 v30, s[44:47], s59 offen lds
  s_add_u32 m0, s56, 12288
  s_add_u32 s59, s64, 589824
  buffer_load_dwordx4 v31, s[44:47], s59 offen lds
  s_add_u32 m0, s56, 13312
  s_add_u32 s59, s64, 638976
  buffer_load_dwordx4 v30, s[44:47], s59 offen lds
  s_add_u32 m0, s56, 14336
  s_add_u32 s59, s64, 688128
  buffer_load_dwordx4 v31, s[44:47], s59 offen lds
  s_add_u32 m0, s56, 15360
  s_add_u32 s59, s64, 737280
  buffer_load_dwordx4 v30, s[44:47], s59 offen lds
  s_lshl_b32 s58, s58, 2
  s_add_u32 s58, s58, s52
  s_lshl_b32 s64, s58, 6
  s_add_u32 s64, s64, 4096
  ds_read_b128 v[160:163], v6 offset:0
  ds_read_b128 v[164:167], v6 offset:64
  ds_read_b128 v[168:171], v6 offset:128
  ds_read_b128 v[172:175], v6 offset:192
  ds_read_b128 v[176:179], v6 offset:256
  ds_read_b128 v[180:183], v6 offset:320
  ds_read_b128 v[184:187], v6 offset:384
  ds_read_b128 v[188:191], v6 offset:448
  ds_read_b128 v[192:195], v6 offset:512
  ds_read_b128 v[196:199], v6 offset:576
  ds_read_b128 v[200:203], v6 offset:640
  ds_read_b128 v[204:207], v6 offset:704
  ds_read_b128 v[208:211], v6 offset:768
  ds_read_b128 v[212:215], v6 offset:832
  ds_read_b128 v[216:219], v6 offset:896
  ds_read_b128 v[220:223], v6 offset:960
  s_waitcnt vmcnt(0) lgkmcnt(0)
  v_mov_b32 v40, 90112
  v_mov_b32 v41, 1
  s_mov_b64 exec, 1
  ds_add_u32 v40, v41 offset:12
  s_mov_b64 exec, -1
  s_mov_b32 s60, 8388608
L_lw5:
  ds_read_b32 v42, v40 offset:12
  s_waitcnt lgkmcnt(0)
  v_cmp_gt_u32 vcc, 4, v42
  s_cbranch_vccz L_pd6
  s_sub_u32 s60, s60, 1
  s_cbranch_scc1 L_pd6
  s_sleep 2
  s_branch L_lw5
L_pd6:
  ds_read_b64_tr_b16 v[64:65], v61 offset:0
  ds_read_b64_tr_b16 v[66:67], v61 offset:512
  ds_read_b64_tr_b16 v[68:69], v61 offset:4096
  ds_read_b64_tr_b16 v[70:71], v61 offset:4608
  ds_read_b64_tr_b16 v[72:73], v61 offset:8192
  ds_read_b64_tr_b16 v[74:75], v61 offset:8704
  ds_read_b64_tr_b16 v[76:77], v61 offset:12288
  ds_read_b64_tr_b16 v[78:79], v61 offset:12800
  ds_read_b64_tr_b16 v[80:81], v61 offset:16384
  ds_read_b64_tr_b16 v[82:83], v61 offset:16896
  ds_read_b64_tr_b16 v[84:85], v61 offset:20480
  ds_read_b64_tr_b16 v[86:87], v61 offset:20992
  ds_read_b64_tr_b16 v[88:89], v61 offset:24576
  ds_read_b64_tr_b16 v[90:91], v61 offset:25088
  ds_read_b64_tr_b16 v[92:93], v61 offset:28672
  ds_read_b64_tr_b16 v[94:95], v61 offset:29184
  ds_read_b64_tr_b16 v[96:97], v61 offset:32768
  ds_read_b64_tr_b16 v[98:99], v61 offset:33280
  ds_read_b64_tr_b16 v[100:101], v61 offset:36864
  ds_read_b64_tr_b16 v[102:103], v61 offset:37376
  ds_read_b64_tr_b16 v[104:105], v61 offset:40960
  ds_read_b64_tr_b16 v[106:107], v61 offset:41472
  ds_read_b64_tr_b16 v[108:109], v61 offset:45056
  ds_read_b64_tr_b16 v[110:111], v61 offset:45568
  ds_read_b64_tr_b16 v[112:113], v61 offset:49152
  ds_read_b64_tr_b16 v[114:115], v61 offset:49664
  ds_read_b64_tr_b16 v[116:117], v61 offset:53248
  ds_read_b64_tr_b16 v[118:119], v61 offset:53760
  ds_read_b64_tr_b16 v[120:121], v61 offset:57344
  ds_read_b64_tr_b16 v[122:123], v61 offset:57856
  ds_read_b64_tr_b16 v[124:125], v61 offset:61440
  ds_read_b64_tr_b16 v[126:127], v61 offset:61952
  s_waitcnt lgkmcnt(15)
  v_mfma_f32_16x16x32_bf16 v[16:19], v[64:67], v[160:163], 0
  v_mfma_f32_16x16x32_bf16 v[20:23], v[68:71], v[164:167], 0
  s_waitcnt lgkmcnt(15)
  v_mfma_f32_16x16x32_bf16 v[16:19], v[72:75], v[168:171], v[16:19]
  v_mfma_f32_16x16x32_bf16 v[20:23], v[76:79], v[172:175], v[20:23]
  s_waitcnt lgkmcnt(15)
  v_mfma_f32_16x16x32_bf16 v[16:19], v[80:83], v[176:179], v[16:19]
  v_mfma_f32_16x16x32_bf16 v[20:23], v[84:87], v[180:183], v[20:23]
  s_waitcnt lgkmcnt(15)
  v_mfma_f32_16x16x32_bf16 v[16:19], v[88:91], v[184:187], v[16:19]
  v_mfma_f32_16x16x32_bf16 v[20:23], v[92:95], v[188:191], v[20:23]
  s_waitcnt lgkmcnt(12)
  v_mfma_f32_16x16x32_bf16 v[16:19], v[96:99], v[192:195], v[16:19]
  v_mfma_f32_16x16x32_bf16 v[20:23], v[100:103], v[196:199], v[20:23]
  s_waitcnt lgkmcnt(8)
  v_mfma_f32_16x16x32_bf16 v[16:19], v[104:107], v[200:203], v[16:19]
  v_mfma_f32_16x16x32_bf16 v[20:23], v[108:111], v[204:207], v[20:23]
  s_waitcnt lgkmcnt(4)
  v_mfma_f32_16x16x32_bf16 v[16:19], v[112:115], v[208:211], v[16:19]
  v_mfma_f32_16x16x32_bf16 v[20:23], v[116:119], v[212:215], v[20:23]
  s_waitcnt lgkmcnt(0)
  v_mfma_f32_16x16x32_bf16 v[16:19], v[120:123], v[216:219], v[16:19]
  v_mfma_f32_16x16x32_bf16 v[20:23], v[124:127], v[220:223], v[20:23]
  s_nop 7
  v_add_f32 v16, v16, v20
  v_add_f32 v17, v17, v21
  v_add_f32 v18, v18, v22
  v_add_f32 v19, v19, v23
  v_cvt_pk_bf16_f32 v12, v16, v17
  v_cvt_pk_bf16_f32 v14, v18, v19
  s_mov_b32 exec_lo, 0x00010001
  s_mov_b32 exec_hi, 0x00010001
  buffer_store_dwordx4 v[12:15], v0, s[40:43], s64 offen sc1
  s_mov_b64 exec, -1
  s_branch L_pnd
L_p2:
  s_lshl_b32 s64, s58, 6
  s_add_u32 s64, s64, 16384
  s_lshl_b32 s59, s52, 8
  v_lshlrev_b32 v3, 2, v0
  v_add_u32 v3, s59, v3
  s_mov_b32 s48, s4
  s_mov_b32 s49, s5
  s_mov_b32 s50, 0x400
  s_mov_b32 s51, 0x20000
  buffer_load_dword v20, v3, s[48:51], 0 offen
  v_add_u32 v60, 65536, v3
  v_lshlrev_b32 v59, 4, v8
  v_add_u32 v59, 65536, v59
  s_lshl_b32 s65, s52, 10
  s_add_u32 s65, s65, 65536
  s_add_u32 s66, s65, 4096
  s_add_u32 s67, s65, 8192
  s_add_u32 s68, s65, 12288
  s_add_u32 s69, s65, 16384
  s_add_u32 s70, s65, 20480
  s_add_u32 s71, s65, 24576
  s_add_u32 s72, s65, 28672
  s_waitcnt vmcnt(17)
  v_lshlrev_b32 v24, 16, v16
  v_and_b32 v25, 0xffff0000, v16
  v_lshlrev_b32 v26, 16, v17
  v_and_b32 v27, 0xffff0000, v17
  v_lshlrev_b32 v28, 16, v18
  v_and_b32 v29, 0xffff0000, v18
  v_lshlrev_b32 v30, 16, v19
  v_and_b32 v31, 0xffff0000, v19
  v_add_f32 v10, v24, v25
  v_mul_f32 v11, v24, v24
  v_fmac_f32 v11, v25, v25
  v_add_f32 v10, v10, v26
  v_fmac_f32 v11, v26, v26
  v_add_f32 v10, v10, v27
  v_fmac_f32 v11, v27, v27
  v_add_f32 v10, v10, v28
  v_fmac_f32 v11, v28, v28
  v_add_f32 v10, v10, v29
  v_fmac_f32 v11, v29, v29
  v_add_f32 v10, v10, v30
  v_fmac_f32 v11, v30, v30
  v_add_f32 v10, v10, v31
  v_fmac_f32 v11, v31, v31
  s_nop 1
  v_permlane32_swap_b32 v10, v11
  v_add_f32 v10, v10, v11
  v_mov_b32 v11, v10
  s_nop 1
  v_permlane16_swap_b32 v10, v11
  v_add_f32 v10, v10, v11
  s_nop 1
  v_add_f32_dpp v10, v10, v10 row_ror:8 row_mask:0xf bank_mask:0xf
  s_nop 1
  v_add_f32_dpp v10, v10, v10 row_ror:4 row_mask:0xf bank_mask:0xf
  s_nop 1
  v_add_f32_dpp v10, v10, v10 quad_perm:[1,0,3,2] row_mask:0xf bank_mask:0xf
  s_nop 1
  v_add_f32_dpp v10, v10, v10 quad_perm:[2,3,0,1] row_mask:0xf bank_mask:0xf
  s_nop 0
  v_readlane_b32 s62, v10, 0
  v_readlane_b32 s63, v10, 32
  v_mov_b32 v12, 0x3b000000
  v_mul_f32 v10, s62, v12
  v_mul_f32 v11, s63, v12
  v_fma_f32 v11, -v10, v10, v11
  v_max_f32 v11, 0, v11
  v_cvt_pk_bf16_f32 v12, v10, v11
  v_lshlrev_b32 v10, 16, v12
  v_and_b32 v11, 0xffff0000, v12
  v_add_f32 v11, 0x3727c5ac, v11
  v_cvt_pk_bf16_f32 v11, v11, v11
  v_and_b32 v11, 0xffff0000, v11
  v_sqrt_f32 v11, v11
  s_nop 0
  v_cvt_pk_bf16_f32 v11, v11, v11
  v_and_b32 v11, 0xffff0000, v11
  v_rcp_f32 v11, v11
  v_mov_b32 v22, v10
  v_mov_b32 v23, v11
  s_waitcnt vmcnt(0)
  s_mov_b32 s60, 524288
L_pm7:
  buffer_load_dwordx4 v[160:163], v2, s[40:43], s65 offen sc1
  buffer_load_dwordx4 v[164:167], v2, s[40:43], s66 offen sc1
  buffer_load_dwordx4 v[168:171], v2, s[40:43], s67 offen sc1
  buffer_load_dwordx4 v[172:175], v2, s[40:43], s68 offen sc1
  buffer_load_dwordx4 v[176:179], v2, s[40:43], s69 offen sc1
  buffer_load_dwordx4 v[180:183], v2, s[40:43], s70 offen sc1
  buffer_load_dwordx4 v[184:187], v2, s[40:43], s71 offen sc1
  buffer_load_dwordx4 v[188:191], v2, s[40:43], s72 offen sc1
  s_waitcnt vmcnt(8)
  v_lshlrev_b32 v24, 16, v20
  v_and_b32 v25, 0xffff0000, v20
  v_sub_f32 v24, v24, v22
  v_sub_f32 v25, v25, v22
  v_cvt_pk_bf16_f32 v12, v24, v25
  v_lshlrev_b32 v24, 16, v12
  v_and_b32 v25, 0xffff0000, v12
  v_mul_f32 v24, v24, v23
  v_mul_f32 v25, v25, v23
  v_cvt_pk_bf16_f32 v12, v24, v25
  v_lshlrev_b32 v24, 16, v12
  v_and_b32 v25, 0xffff0000, v12
  s_waitcnt vmcnt(0)
  v_xor_b32 v10, s55, v161
  v_xor_b32 v11, s55, v163
  v_or_b32 v10, v10, v11
  v_xor_b32 v11, s55, v165
  v_or_b32 v10, v10, v11
  v_xor_b32 v11, s55, v167
  v_or_b32 v10, v10, v11
  v_xor_b32 v11, s55, v169
  v_or_b32 v10, v10, v11
  v_xor_b32 v11, s55, v171
  v_or_b32 v10, v10, v11
  v_xor_b32 v11, s55, v173
  v_or_b32 v10, v10, v11
  v_xor_b32 v11, s55, v175
  v_or_b32 v10, v10, v11
  v_xor_b32 v11, s55, v177
  v_or_b32 v10, v10, v11
  v_xor_b32 v11, s55, v179
  v_or_b32 v10, v10, v11
  v_xor_b32 v11, s55, v181
  v_or_b32 v10, v10, v11
  v_xor_b32 v11, s55, v183
  v_or_b32 v10, v10, v11
  v_xor_b32 v11, s55, v185
  v_or_b32 v10, v10, v11
  v_xor_b32 v11, s55, v187
  v_or_b32 v10, v10, v11
  v_xor_b32 v11, s55, v189
  v_or_b32 v10, v10, v11
  v_xor_b32 v11, s55, v191
  v_or_b32 v10, v10, v11
  v_cmp_ne_u32 vcc, 0, v10
  s_cbranch_vccz L_pd8
  s_sub_u32 s60, s60, 1
  s_cbranch_scc1 L_pd8
  s_sleep 1
  s_branch L_pm7
L_pd8:
  v_add_f32 v26, v160, v168
  v_add_f32 v30, v176, v184
  v_add_f32 v26, v26, v30
  v_add_f32 v27, v162, v170
  v_add_f32 v31, v178, v186
  v_add_f32 v27, v27, v31
  v_cvt_pk_bf16_f32 v12, v26, v27
  v_lshlrev_b32 v26, 16, v12
  v_and_b32 v27, 0xffff0000, v12
  v_add_f32 v28, v164, v172
  v_add_f32 v30, v180, v188
  v_add_f32 v28, v28, v30
  v_add_f32 v29, v166, v174
  v_add_f32 v31, v182, v190
  v_add_f32 v29, v29, v31
  v_cvt_pk_bf16_f32 v12, v28, v29
  v_lshlrev_b32 v28, 16, v12
  v_and_b32 v29, 0xffff0000, v12
  v_add_f32 v28, 1.0, v28
  v_add_f32 v29, 1.0, v29
  v_cvt_pk_bf16_f32 v12, v28, v29
  v_lshlrev_b32 v28, 16, v12
  v_and_b32 v29, 0xffff0000, v12
  v_mul_f32 v24, v24, v28
  v_mul_f32 v25, v25, v29
  v_cvt_pk_bf16_f32 v12, v24, v25
  v_lshlrev_b32 v24, 16, v12
  v_and_b32 v25, 0xffff0000, v12
  v_add_f32 v24, v24, v26
  v_add_f32 v25, v25, v27
  v_cvt_pk_bf16_f32 v24, v24, v25
  ds_write_b32 v60, v24
  s_waitcnt lgkmcnt(0)
  s_barrier
  ds_read_b128 v[160:163], v59 offset:0
  ds_read_b64_tr_b16 v[64:65], v61 offset:0
  ds_read_b64_tr_b16 v[66:67], v61 offset:512
  ds_read_b128 v[164:167], v59 offset:64
  ds_read_b64_tr_b16 v[68:69], v61 offset:4096
  ds_read_b64_tr_b16 v[70:71], v61 offset:4608
  ds_read_b128 v[168:171], v59 offset:128
  ds_read_b64_tr_b16 v[72:73], v61 offset:8192
  ds_read_b64_tr_b16 v[74:75], v61 offset:8704
  ds_read_b128 v[172:175], v59 offset:192
  ds_read_b64_tr_b16 v[76:77], v61 offset:12288
  ds_read_b64_tr_b16 v[78:79], v61 offset:12800
  s_waitcnt lgkmcnt(9)
  v_mfma_f32_16x16x32_bf16 v[16:19], v[64:67], v[160:163], 0
  ds_read_b128 v[176:179], v59 offset:256
  ds_read_b64_tr_b16 v[80:81], v61 offset:16384
  ds_read_b64_tr_b16 v[82:83], v61 offset:16896
  s_waitcnt lgkmcnt(9)
  v_mfma_f32_16x16x32_bf16 v[16:19], v[68:71], v[164:167], v[16:19]
  ds_read_b128 v[180:183], v59 offset:320
  ds_read_b64_tr_b16 v[84:85], v61 offset:20480
  ds_read_b64_tr_b16 v[86:87], v61 offset:20992
  s_waitcnt lgkmcnt(9)
  v_mfma_f32_16x16x32_bf16 v[16:19], v[72:75], v[168:171], v[16:19]
  ds_read_b128 v[184:187], v59 offset:384
  ds_read_b64_tr_b16 v[88:89], v61 offset:24576
  ds_read_b64_tr_b16 v[90:91], v61 offset:25088
  s_waitcnt lgkmcnt(9)
  v_mfma_f32_16x16x32_bf16 v[16:19], v[76:79], v[172:175], v[16:19]
  ds_read_b128 v[188:191], v59 offset:448
  ds_read_b64_tr_b16 v[92:93], v61 offset:28672
  ds_read_b64_tr_b16 v[94:95], v61 offset:29184
  s_waitcnt lgkmcnt(9)
  v_mfma_f32_16x16x32_bf16 v[16:19], v[80:83], v[176:179], v[16:19]
  ds_read_b128 v[192:195], v59 offset:512
  ds_read_b64_tr_b16 v[96:97], v61 offset:32768
  ds_read_b64_tr_b16 v[98:99], v61 offset:33280
  s_waitcnt lgkmcnt(9)
  v_mfma_f32_16x16x32_bf16 v[16:19], v[84:87], v[180:183], v[16:19]
  ds_read_b128 v[196:199], v59 offset:576
  ds_read_b64_tr_b16 v[100:101], v61 offset:36864
  ds_read_b64_tr_b16 v[102:103], v61 offset:37376
  s_waitcnt lgkmcnt(9)
  v_mfma_f32_16x16x32_bf16 v[16:19], v[88:91], v[184:187], v[16:19]
  ds_read_b128 v[200:203], v59 offset:640
  ds_read_b64_tr_b16 v[104:105], v61 offset:40960
  ds_read_b64_tr_b16 v[106:107], v61 offset:41472
  s_waitcnt lgkmcnt(9)
  v_mfma_f32_16x16x32_bf16 v[16:19], v[92:95], v[188:191], v[16:19]
  ds_read_b128 v[204:207], v59 offset:704
  ds_read_b64_tr_b16 v[108:109], v61 offset:45056
  ds_read_b64_tr_b16 v[110:111], v61 offset:45568
  s_waitcnt lgkmcnt(9)
  v_mfma_f32_16x16x32_bf16 v[16:19], v[96:99], v[192:195], v[16:19]
  ds_read_b128 v[208:211], v59 offset:768
  ds_read_b64_tr_b16 v[112:113], v61 offset:49152
  ds_read_b64_tr_b16 v[114:115], v61 offset:49664
  s_waitcnt lgkmcnt(9)
  v_mfma_f32_16x16x32_bf16 v[16:19], v[100:103], v[196:199], v[16:19]
  ds_read_b128 v[212:215], v59 offset:832
  ds_read_b64_tr_b16 v[116:117], v61 offset:53248
  ds_read_b64_tr_b16 v[118:119], v61 offset:53760
  s_waitcnt lgkmcnt(9)
  v_mfma_f32_16x16x32_bf16 v[16:19], v[104:107], v[200:203], v[16:19]
  ds_read_b128 v[216:219], v59 offset:896
  ds_read_b64_tr_b16 v[120:121], v61 offset:57344
  ds_read_b64_tr_b16 v[122:123], v61 offset:57856
  s_waitcnt lgkmcnt(9)
  v_mfma_f32_16x16x32_bf16 v[16:19], v[108:111], v[204:207], v[16:19]
  ds_read_b128 v[220:223], v59 offset:960
  ds_read_b64_tr_b16 v[124:125], v61 offset:61440
  ds_read_b64_tr_b16 v[126:127], v61 offset:61952
  s_waitcnt lgkmcnt(9)
  v_mfma_f32_16x16x32_bf16 v[16:19], v[112:115], v[208:211], v[16:19]
  s_waitcnt lgkmcnt(6)
  v_mfma_f32_16x16x32_bf16 v[16:19], v[116:119], v[212:215], v[16:19]
  s_waitcnt lgkmcnt(3)
  v_mfma_f32_16x16x32_bf16 v[16:19], v[120:123], v[216:219], v[16:19]
  s_waitcnt lgkmcnt(0)
  v_mfma_f32_16x16x32_bf16 v[16:19], v[124:127], v[220:223], v[16:19]
  s_nop 7
  v_cvt_pk_bf16_f32 v12, v16, v17
  v_cvt_pk_bf16_f32 v14, v18, v19
  s_mov_b32 exec_lo, 0x00010001
  s_mov_b32 exec_hi, 0x00010001
  buffer_store_dwordx4 v[12:15], v0, s[40:43], s64 offen sc1
  s_mov_b64 exec, -1
  s_barrier
  s_branch L_qg
L_clr:
  s_nop 1
  v_mov_b32 v12, -1
  v_mov_b32 v13, -1
  v_mov_b32 v14, -1
  v_mov_b32 v15, -1
  s_lshl_b32 s58, s53, 2
  s_add_u32 s58, s58, s54
  s_sub_u32 s58, s58, 24
  s_lshl_b32 s58, s58, 2
  s_add_u32 s58, s58, s52
  s_mul_i32 s58, s58, 6400
  s_add_u32 s58, s58, 262144
  buffer_store_dwordx4 v[12:15], v2, s[40:43], s58 offen offset:0 sc1
  buffer_store_dwordx4 v[12:15], v2, s[40:43], s58 offen offset:1024 sc1
  buffer_store_dwordx4 v[12:15], v2, s[40:43], s58 offen offset:2048 sc1
  buffer_store_dwordx4 v[12:15], v2, s[40:43], s58 offen offset:3072 sc1
  s_add_u32 s58, s58, 4096
  buffer_store_dwordx4 v[12:15], v2, s[40:43], s58 offen offset:0 sc1
  buffer_store_dwordx4 v[12:15], v2, s[40:43], s58 offen offset:1024 sc1
  s_mov_b32 exec_lo, 0xffff
  s_mov_b32 exec_hi, 0x0
  buffer_store_dwordx4 v[12:15], v2, s[40:43], s58 offen offset:2048 sc1
  s_mov_b64 exec, -1
  v_mov_b32 v16, 1
  v_mov_b32 v17, 0
  s_mov_b32 s44, s28
  s_mov_b32 s45, s29
  s_mov_b32 s46, 0x100
  s_mov_b32 s47, 0x20000
  s_barrier
  s_waitcnt vmcnt(0)
  s_mov_b64 exec, 1
  buffer_atomic_add v16, v17, s[44:47], 0 offen sc1
  s_mov_b64 exec, -1
  s_branch L_qg
L_bx:
  s_waitcnt vmcnt(0)
  s_barrier
L_qg:
  s_cmp_ge_u32 s54, 23
  s_cbranch_scc1 L_qg2
  s_cmp_ge_u32 s54, 16
  s_cbranch_scc1 L_stf
  s_lshr_b32 s64, s54, 3
  s_lshl_b32 s64, s64, 2
  s_add_u32 s64, s64, s52
  s_lshl_b32 s65, s53, 3
  s_add_u32 s65, s65, s64
  s_and_b32 s66, s54, 7
  s_lshl_b32 s67, s65, 16
  s_lshl_b32 s58, s66, 7
  s_add_u32 s67, s67, s58
  s_mov_b32 s44, s12
  s_mov_b32 s45, s13
  s_mov_b32 s46, 0x400000
  s_mov_b32 s47, 0x20000
  v_lshrrev_b32 v31, 3, v0
  s_mov_b32 s59, 1024
  v_mul_lo_u32 v31, v31, s59
  v_xor_b32 v30, 64, v62
  v_add_u32 v30, v30, v31
  v_add_u32 v31, v31, v62
  s_branch L_qg2
L_stf:
  s_mul_i32 s64, s53, 7
  s_add_u32 s64, s64, s54
  s_sub_u32 s64, s64, 16
  s_and_b32 s58, s52, 1
  s_cselect_b64 s[44:45], s[18:19], s[16:17]
  s_mov_b32 s46, 1835008
  s_mov_b32 s47, 0x20000
  s_lshl_b32 s67, s58, 15
  s_lshr_b32 s58, s52, 1
  s_lshl_b32 s59, s58, 10
  s_add_u32 s67, s67, s59
  s_mul_i32 s66, s58, 57344
  s_lshl_b32 s58, s64, 6
  s_add_u32 s66, s66, s58
  v_lshrrev_b32 v31, 2, v0
  s_mov_b32 s59, 3584
  v_mul_lo_u32 v31, v31, s59
  v_lshrrev_b32 v10, 4, v0
  v_and_b32 v10, 2, v10
  v_xor_b32 v10, v10, v0
  s_and_b32 s58, s52, 1
  v_xor_b32 v10, s58, v10
  v_and_b32 v10, 3, v10
  v_lshl_add_u32 v31, v10, 4, v31
  s_add_u32 m0, s67, 0
  s_add_u32 s59, s66, 0
  buffer_load_dwordx4 v31, s[44:47], s59 offen lds
  s_add_u32 m0, s67, 2048
  s_add_u32 s59, s66, 114688
  buffer_load_dwordx4 v31, s[44:47], s59 offen lds
  s_add_u32 m0, s67, 4096
  s_add_u32 s59, s66, 229376
  buffer_load_dwordx4 v31, s[44:47], s59 offen lds
  s_add_u32 m0, s67, 6144
  s_add_u32 s59, s66, 344064
  buffer_load_dwordx4 v31, s[44:47], s59 offen lds
  s_add_u32 m0, s67, 8192
  s_add_u32 s59, s66, 458752
  buffer_load_dwordx4 v31, s[44:47], s59 offen lds
  s_add_u32 m0, s67, 10240
  s_add_u32 s59, s66, 573440
  buffer_load_dwordx4 v31, s[44:47], s59 offen lds
L_qg2:
  s_cmp_eq_u32 s52, 3
  s_cbranch_scc0 L_b1
  v_lshlrev_b32 v3, 1, v1
  s_lshr_b32 s58, s2, 5
  s_lshl_b32 s58, s58, 11
  s_add_u32 s58, s58, 16384
  v_mov_b32 v40, 90112
  s_mov_b32 s60, 8388608
L_lw9:
  ds_read_b32 v42, v40 offset:16
  s_waitcnt lgkmcnt(0)
  v_cmp_gt_u32 vcc, 1, v42
  s_cbranch_vccz L_pd10
  s_sub_u32 s60, s60, 1
  s_cbranch_scc1 L_pd10
  s_sleep 2
  s_branch L_lw9
L_pd10:
  s_mov_b32 s60, 524288
L_pq11:
  buffer_load_dwordx4 v[16:19], v3, s[40:43], s58 offen sc1
  buffer_load_dwordx4 v[20:23], v3, s[40:43], s58 offen offset:16 sc1
  s_waitcnt vmcnt(0)
  v_xor_b32 v10, s55, v17
  v_xor_b32 v11, s55, v19
  v_or_b32 v10, v10, v11
  v_xor_b32 v11, s55, v21
  v_or_b32 v10, v10, v11
  v_xor_b32 v11, s55, v23
  v_or_b32 v10, v10, v11
  v_cmp_ne_u32 vcc, 0, v10
  s_cbranch_vccz L_pd12
  s_sub_u32 s60, s60, 1
  s_cbranch_scc1 L_pd12
  s_sleep 1
  s_branch L_pq11
L_pd12:
  v_mov_b32 v17, v18
  v_mov_b32 v18, v20
  v_mov_b32 v19, v22
  v_add_u32 v3, 69632, v2
  ds_write_b128 v3, v[16:19]
  s_waitcnt lgkmcnt(0)
  s_barrier
  s_mov_b32 s48, s28
  s_mov_b32 s49, s29
  s_mov_b32 s50, 0x100
  s_mov_b32 s51, 0x20000
  v_mov_b32 v17, 0
  s_mov_b32 s60, 524288
L_pc13:
  buffer_load_dword v16, v17, s[48:51], 0 offen sc1
  s_waitcnt vmcnt(0)
  v_cmp_gt_u32 vcc, 0x80, v16
  s_cbranch_vccz L_pd14
  s_sub_u32 s60, s60, 1
  s_cbranch_scc1 L_pd14
  s_sleep 4
  s_branch L_pc13
L_pd14:
  s_branch L_role
L_b1:
  s_barrier
L_role:
  s_cmp_lt_u32 s54, 16
  s_cbranch_scc1 L_e1
  s_cmp_lt_u32 s54, 23
  s_cbranch_scc1 L_ffn
  s_cmp_ge_u32 s54, 28
  s_cbranch_scc1 L_pn
L_pnd:
  s_cmp_eq_u32 s52, 3
  s_cbranch_scc0 L_wend
L_bal:
  s_setprio 0
  v_mov_b32 v40, 90112
  s_cmp_lt_u32 s54, 16
  s_cbranch_scc1 L_bal2
  s_cmp_ge_u32 s54, 23
  s_cbranch_scc1 L_bal2
  v_mov_b32 v41, 1
  s_mov_b64 exec, 1
  ds_add_u32 v40, v41 offset:12
  s_mov_b64 exec, -1
  s_mov_b32 s60, 8388608
L_lw15:
  ds_read_b32 v42, v40 offset:12
  s_waitcnt lgkmcnt(0)
  v_cmp_gt_u32 vcc, 4, v42
  s_cbranch_vccz L_pd16
  s_sub_u32 s60, s60, 1
  s_cbranch_scc1 L_pd16
  s_sleep 2
  s_branch L_lw15
L_pd16:
  v_and_b32 v10, 1, v0
  v_lshl_add_u32 v10, v10, 10, v6
  ds_read_b128 v[160:163], v10 offset:1024
  ds_read_b128 v[164:167], v10 offset:1088
  ds_read_b128 v[168:171], v10 offset:1152
  ds_read_b128 v[172:175], v10 offset:1216
  ds_read_b128 v[176:179], v10 offset:1280
  ds_read_b128 v[180:183], v10 offset:1344
  ds_read_b128 v[184:187], v10 offset:1408
  ds_read_b128 v[188:191], v10 offset:1472
  ds_read_b128 v[192:195], v10 offset:1536
  ds_read_b128 v[196:199], v10 offset:1600
  ds_read_b128 v[200:203], v10 offset:1664
  ds_read_b128 v[204:207], v10 offset:1728
  ds_read_b128 v[208:211], v10 offset:1792
  ds_read_b128 v[212:215], v10 offset:1856
  ds_read_b128 v[216:219], v10 offset:1920
  ds_read_b128 v[220:223], v10 offset:1984
  v_mov_b32 v52, 0
  v_mov_b32 v53, 0
  v_mov_b32 v54, 0
  v_mov_b32 v55, 0
  ds_read_b64_tr_b16 v[64:65], v5 offset:0
  ds_read_b64_tr_b16 v[66:67], v5 offset:256
  ds_read_b64_tr_b16 v[68:69], v5 offset:2048
  ds_read_b64_tr_b16 v[70:71], v5 offset:2304
  ds_read_b64_tr_b16 v[72:73], v5 offset:4096
  ds_read_b64_tr_b16 v[74:75], v5 offset:4352
  ds_read_b64_tr_b16 v[76:77], v5 offset:6144
  ds_read_b64_tr_b16 v[78:79], v5 offset:6400
  ds_read_b64_tr_b16 v[80:81], v5 offset:8192
  ds_read_b64_tr_b16 v[82:83], v5 offset:8448
  ds_read_b64_tr_b16 v[84:85], v5 offset:10240
  ds_read_b64_tr_b16 v[86:87], v5 offset:10496
  s_waitcnt lgkmcnt(10)
  v_mfma_f32_16x16x32_bf16 v[52:55], v[64:67], v[160:163], v[52:55]
  s_waitcnt lgkmcnt(8)
  v_mfma_f32_16x16x32_bf16 v[52:55], v[68:71], v[164:167], v[52:55]
  s_waitcnt lgkmcnt(6)
  v_mfma_f32_16x16x32_bf16 v[52:55], v[72:75], v[168:171], v[52:55]
  s_waitcnt lgkmcnt(4)
  v_mfma_f32_16x16x32_bf16 v[52:55], v[76:79], v[172:175], v[52:55]
  s_waitcnt lgkmcnt(2)
  v_mfma_f32_16x16x32_bf16 v[52:55], v[80:83], v[176:179], v[52:55]
  s_waitcnt lgkmcnt(0)
  v_mfma_f32_16x16x32_bf16 v[52:55], v[84:87], v[180:183], v[52:55]
L_bal2:
  s_cmp_eq_u32 s52, 3
  s_cbranch_scc0 L_balq
  s_mov_b32 s101, 112
  s_cmp_ge_u32 s54, 8
  s_cselect_b32 s101, 144, s101
  s_cmp_ge_u32 s54, 16
  s_cselect_b32 s101, 136, s101
  s_cmp_ge_u32 s54, 23
  s_cselect_b32 s101, 136, s101
  s_cmp_ge_u32 s54, 24
  s_cselect_b32 s101, 120, s101
  s_cmp_ge_u32 s54, 28
  s_cselect_b32 s101, 120, s101
  s_mov_b32 s60, 8388608
L_pw17:
  ds_read_b128 v[44:47], v40 offset:32
  s_memrealtime s[62:63]
  s_waitcnt lgkmcnt(0)
  v_add3_u32 v44, v44, v45, v46
  v_add_u32 v44, v44, v47
  s_sub_u32 s63, s62, s100
  s_cmp_ge_u32 s63, 2850
  s_cbranch_scc1 L_pwd18
  v_cmp_gt_u32 vcc, s101, v44
  s_cbranch_vccz L_pd19
  s_sub_u32 s60, s60, 1
  s_cbranch_scc1 L_pd19
  s_sleep 4
  s_branch L_pw17
L_pd19:
L_pwd18:
  v_readfirstlane_b32 s63, v44
  s_nop 0
  s_sub_u32 s63, s101, s63
  s_mul_i32 s63, s63, 14
  s_add_u32 s62, s62, s63
  s_lshl_b32 s59, s2, 7
  s_add_u32 s59, s59, 32768
  s_lshr_b32 s58, s2, 5
  s_lshl_b32 s58, s58, 12
  s_add_u32 s58, s58, 32768
  s_and_b32 s61, s2, 31
  v_lshlrev_b32 v41, 3, v0
  v_mov_b32 v43, s55
  s_sub_u32 s63, s54, 16
  s_cmp_lt_u32 s63, 7
  s_cselect_b32 s63, 50, 0
  s_add_u32 s62, s62, s63
  s_cmp_lt_u32 s54, 16
  s_cselect_b32 s63, 25, 0
  s_add_u32 s62, s62, s63
  v_mov_b32 v42, s62
  s_mov_b64 exec, 0xffff
  buffer_store_dwordx2 v[42:43], v41, s[40:43], s59 offen sc1
  s_mov_b64 exec, -1
  v_and_b32 v41, 31, v0
  v_lshlrev_b32 v41, 7, v41
  s_add_u32 s101, s101, 24
  s_mov_b32 s60, 8388608
L_pw20:
  ds_read_b128 v[44:47], v40 offset:32
  s_waitcnt lgkmcnt(0)
  v_add3_u32 v44, v44, v45, v46
  v_add_u32 v44, v44, v47
  v_cmp_gt_u32 vcc, s101, v44
  s_cbranch_vccz L_pd22
  s_sub_u32 s60, s60, 1
  s_cbranch_scc1 L_pd22
  s_sleep 4
  s_branch L_pw20
L_pd22:
L_pwd21:
  s_mov_b32 s60, 524288
L_pb23:
  buffer_load_dwordx2 v[44:45], v41, s[40:43], s58 offen sc1
  s_mov_b64 exec, -1
  s_waitcnt vmcnt(0)
  v_cmp_ne_u32 vcc, s55, v45
  s_cbranch_vccz L_pd24
  s_sub_u32 s60, s60, 1
  s_cbranch_scc1 L_pd24
  s_mov_b64 exec, vcc
  s_sleep 4
  s_branch L_pb23
L_pd24:
  v_readlane_b32 s59, v44, 0
  s_nop 1
  v_subrev_u32 v44, s59, v44
  v_cvt_f32_i32 v44, v44
  v_mov_b32 v46, v44
  s_nop 1
  v_add_f32_dpp v46, v46, v46 row_shr:1 row_mask:0xf bank_mask:0xf bound_ctrl:0
  s_nop 1
  v_add_f32_dpp v46, v46, v46 row_shr:2 row_mask:0xf bank_mask:0xf bound_ctrl:0
  s_nop 1
  v_add_f32_dpp v46, v46, v46 row_shr:4 row_mask:0xf bank_mask:0xf bound_ctrl:0
  s_nop 1
  v_add_f32_dpp v46, v46, v46 row_shr:8 row_mask:0xf bank_mask:0xf bound_ctrl:0
  s_nop 1
  v_add_f32_dpp v46, v46, v46 row_bcast:15 row_mask:0xa bank_mask:0xf
  s_nop 0
  v_readlane_b32 s59, v46, 31
  v_mov_b32 v47, 0x3e924925
  v_mov_b32 v48, 0x45400000
  v_fma_f32 v47, s59, v47, v48
  v_mov_b32 v48, 0xc1124925
  v_fma_f32 v46, v44, v48, v47
  v_max_f32 v46, 0, v46
  v_min_f32 v46, 0x46100000, v46
  v_rndne_f32 v46, v46
  s_nop 1
  v_add_f32_dpp v46, v46, v46 row_shr:1 row_mask:0xf bank_mask:0xf bound_ctrl:0
  s_nop 1
  v_add_f32_dpp v46, v46, v46 row_shr:2 row_mask:0xf bank_mask:0xf bound_ctrl:0
  s_nop 1
  v_add_f32_dpp v46, v46, v46 row_shr:4 row_mask:0xf bank_mask:0xf bound_ctrl:0
  s_nop 1
  v_add_f32_dpp v46, v46, v46 row_shr:8 row_mask:0xf bank_mask:0xf bound_ctrl:0
  s_nop 1
  v_add_f32_dpp v46, v46, v46 row_bcast:15 row_mask:0xa bank_mask:0xf
  s_nop 0
  v_readlane_b32 s59, v46, 31
  s_nop 1
  v_rcp_f32 v47, s59
  s_nop 0
  v_mul_f32 v47, 0x43c00000, v47
  v_mul_f32 v46, v46, v47
  v_rndne_f32 v46, v46
  v_cvt_u32_f32 v46, v46
  v_min_u32 v46, 384, v46
  s_sub_u32 s59, s61, 1
  s_and_b32 s59, s59, 31
  v_readlane_b32 s62, v46, s59
  v_readlane_b32 s63, v46, s61
  s_cmp_eq_u32 s61, 0
  s_cselect_b32 s62, 0, s62
  s_cmp_eq_u32 s61, 31
  s_cselect_b32 s63, 384, s63
  s_or_b32 s63, s63, 0x10000
  v_mov_b32 v44, s62
  v_mov_b32 v45, s63
  v_mov_b32 v40, 90112
  ds_write_b64 v40, v[44:45]
  s_waitcnt lgkmcnt(0)
L_balq:
  s_setprio 0
  s_cmp_ge_u32 s54, 23
  s_cbranch_scc1 L_wend
  s_mov_b32 s60, 8388608
L_lw25:
  ds_read_b32 v42, v40 offset:4
  s_waitcnt lgkmcnt(0)
  v_cmp_gt_u32 vcc, 1, v42
  s_cbranch_vccz L_pd26
  s_sub_u32 s60, s60, 1
  s_cbranch_scc1 L_pd26
  s_sleep 24
  s_branch L_lw25
L_pd26:
  s_mov_b32 s101, 262144
  s_mov_b32 s60, 8388608
L_pw27:
  ds_read_b128 v[44:47], v40 offset:32
  s_waitcnt lgkmcnt(0)
  v_add3_u32 v44, v44, v45, v46
  v_add_u32 v44, v44, v47
  v_cmp_gt_u32 vcc, s101, v44
  s_cbranch_vccz L_pd29
  s_sub_u32 s60, s60, 1
  s_cbranch_scc1 L_pd29
  s_sleep 2
  s_branch L_pw27
L_pd29:
L_pwd28:
  s_cmp_lt_u32 s54, 16
  s_cbranch_scc1 L_e1b
  s_cmp_lt_u32 s54, 23
  s_cbranch_scc1 L_ffnb
L_wend:
  s_endpgm
L_stream2:
  s_mul_i32 s58, s3, 9216
  s_add_u32 s63, s58, 107520
  v_lshlrev_b32 v3, 2, v0
  v_add_u32 v3, s63, v3
  s_lshl_b32 s58, s72, 8
  v_add_u32 v3, s58, v3
  s_add_u32 s53, s52, 65536
  s_add_u32 s65, s53, 65536
  s_mov_b32 s52, s52
  s_mov_b32 s53, s53
  s_mov_b32 s62, s65
  s_lshl_b32 s58, s3, 12
  v_add_u32 v62, s58, v2
  s_waitcnt vmcnt(52)
  v_mfma_f32_16x16x32_bf16 v[28:31], v[64:67], v[4:7], 0
  v_mfma_f32_16x16x32_bf16 v[32:35], v[68:71], v[4:7], 0
  v_mfma_f32_16x16x32_bf16 v[36:39], v[72:75], v[4:7], 0
  v_mfma_f32_16x16x32_bf16 v[40:43], v[76:79], v[4:7], 0
  buffer_load_dwordx4 v[64:67], v1, s[32:35], s52 offen offset:0 nt
  buffer_load_dwordx4 v[68:71], v1, s[32:35], s52 offen offset:1024 nt
  buffer_load_dwordx4 v[72:75], v1, s[32:35], s52 offen offset:2048 nt
  buffer_load_dwordx4 v[76:79], v1, s[32:35], s52 offen offset:3072 nt
  s_nop 0
  v_mul_f32_dpp v19, v28, v24 quad_perm:[0,0,0,0] row_mask:0xf bank_mask:0xf
  v_fmac_f32_dpp v19, v29, v24 quad_perm:[1,1,1,1] row_mask:0xf bank_mask:0xf
  v_fmac_f32_dpp v19, v30, v24 quad_perm:[2,2,2,2] row_mask:0xf bank_mask:0xf
  v_fmac_f32_dpp v19, v31, v24 quad_perm:[3,3,3,3] row_mask:0xf bank_mask:0xf
  v_fmac_f32_dpp v19, v32, v25 quad_perm:[0,0,0,0] row_mask:0xf bank_mask:0xf
  v_fmac_f32_dpp v19, v33, v25 quad_perm:[1,1,1,1] row_mask:0xf bank_mask:0xf
  v_fmac_f32_dpp v19, v34, v25 quad_perm:[2,2,2,2] row_mask:0xf bank_mask:0xf
  v_fmac_f32_dpp v19, v35, v25 quad_perm:[3,3,3,3] row_mask:0xf bank_mask:0xf
  v_fmac_f32_dpp v19, v36, v26 quad_perm:[0,0,0,0] row_mask:0xf bank_mask:0xf
  v_fmac_f32_dpp v19, v37, v26 quad_perm:[1,1,1,1] row_mask:0xf bank_mask:0xf
  v_fmac_f32_dpp v19, v38, v26 quad_perm:[2,2,2,2] row_mask:0xf bank_mask:0xf
  v_fmac_f32_dpp v19, v39, v26 quad_perm:[3,3,3,3] row_mask:0xf bank_mask:0xf
  v_fmac_f32_dpp v19, v40, v27 quad_perm:[0,0,0,0] row_mask:0xf bank_mask:0xf
  v_fmac_f32_dpp v19, v41, v27 quad_perm:[1,1,1,1] row_mask:0xf bank_mask:0xf
  v_fmac_f32_dpp v19, v42, v27 quad_perm:[2,2,2,2] row_mask:0xf bank_mask:0xf
  v_fmac_f32_dpp v19, v43, v27 quad_perm:[3,3,3,3] row_mask:0xf bank_mask:0xf
  v_cvt_pk_bf16_f32 v19, v19, v19
  v_and_b32 v19, 0xffff0000, v19
  v_mul_f32 v19, s56, v19
  v_cvt_pk_bf16_f32 v19, v19, v19
  v_and_b32 v19, 0xffff0000, v19
  v_max_f32 v16, v16, v19
  ds_write_b32 v3, v19
  v_add_u32 v3, 256, v3
  s_waitcnt vmcnt(52)
  v_mfma_f32_16x16x32_bf16 v[28:31], v[80:83], v[4:7], 0
  v_mfma_f32_16x16x32_bf16 v[32:35], v[84:87], v[4:7], 0
  v_mfma_f32_16x16x32_bf16 v[36:39], v[88:91], v[4:7], 0
  v_mfma_f32_16x16x32_bf16 v[40:43], v[92:95], v[4:7], 0
  buffer_load_dwordx4 v[80:83], v1, s[32:35], s53 offen offset:0 nt
  buffer_load_dwordx4 v[84:87], v1, s[32:35], s53 offen offset:1024 nt
  s_nop 2
  v_mul_f32_dpp v19, v28, v24 quad_perm:[0,0,0,0] row_mask:0xf bank_mask:0xf
  v_fmac_f32_dpp v19, v29, v24 quad_perm:[1,1,1,1] row_mask:0xf bank_mask:0xf
  v_fmac_f32_dpp v19, v30, v24 quad_perm:[2,2,2,2] row_mask:0xf bank_mask:0xf
  v_fmac_f32_dpp v19, v31, v24 quad_perm:[3,3,3,3] row_mask:0xf bank_mask:0xf
  v_fmac_f32_dpp v19, v32, v25 quad_perm:[0,0,0,0] row_mask:0xf bank_mask:0xf
  v_fmac_f32_dpp v19, v33, v25 quad_perm:[1,1,1,1] row_mask:0xf bank_mask:0xf
  v_fmac_f32_dpp v19, v34, v25 quad_perm:[2,2,2,2] row_mask:0xf bank_mask:0xf
  v_fmac_f32_dpp v19, v35, v25 quad_perm:[3,3,3,3] row_mask:0xf bank_mask:0xf
  v_fmac_f32_dpp v19, v36, v26 quad_perm:[0,0,0,0] row_mask:0xf bank_mask:0xf
  v_fmac_f32_dpp v19, v37, v26 quad_perm:[1,1,1,1] row_mask:0xf bank_mask:0xf
  v_fmac_f32_dpp v19, v38, v26 quad_perm:[2,2,2,2] row_mask:0xf bank_mask:0xf
  v_fmac_f32_dpp v19, v39, v26 quad_perm:[3,3,3,3] row_mask:0xf bank_mask:0xf
  v_fmac_f32_dpp v19, v40, v27 quad_perm:[0,0,0,0] row_mask:0xf bank_mask:0xf
  v_fmac_f32_dpp v19, v41, v27 quad_perm:[1,1,1,1] row_mask:0xf bank_mask:0xf
  v_fmac_f32_dpp v19, v42, v27 quad_perm:[2,2,2,2] row_mask:0xf bank_mask:0xf
  v_fmac_f32_dpp v19, v43, v27 quad_perm:[3,3,3,3] row_mask:0xf bank_mask:0xf
  v_cvt_pk_bf16_f32 v19, v19, v19
  v_and_b32 v19, 0xffff0000, v19
  v_mul_f32 v19, s56, v19
  v_cvt_pk_bf16_f32 v19, v19, v19
  v_and_b32 v19, 0xffff0000, v19
  v_max_f32 v16, v16, v19
  ds_write_b32 v3, v19
  v_add_u32 v3, 256, v3
  s_waitcnt vmcnt(50)
  v_mfma_f32_16x16x32_bf16 v[28:31], v[96:99], v[4:7], 0
  v_mfma_f32_16x16x32_bf16 v[32:35], v[100:103], v[4:7], 0
  v_mfma_f32_16x16x32_bf16 v[36:39], v[104:107], v[4:7], 0
  v_mfma_f32_16x16x32_bf16 v[40:43], v[108:111], v[4:7], 0
  s_nop 4
  v_mul_f32_dpp v19, v28, v24 quad_perm:[0,0,0,0] row_mask:0xf bank_mask:0xf
  v_fmac_f32_dpp v19, v29, v24 quad_perm:[1,1,1,1] row_mask:0xf bank_mask:0xf
  v_fmac_f32_dpp v19, v30, v24 quad_perm:[2,2,2,2] row_mask:0xf bank_mask:0xf
  v_fmac_f32_dpp v19, v31, v24 quad_perm:[3,3,3,3] row_mask:0xf bank_mask:0xf
  v_fmac_f32_dpp v19, v32, v25 quad_perm:[0,0,0,0] row_mask:0xf bank_mask:0xf
  v_fmac_f32_dpp v19, v33, v25 quad_perm:[1,1,1,1] row_mask:0xf bank_mask:0xf
  v_fmac_f32_dpp v19, v34, v25 quad_perm:[2,2,2,2] row_mask:0xf bank_mask:0xf
  v_fmac_f32_dpp v19, v35, v25 quad_perm:[3,3,3,3] row_mask:0xf bank_mask:0xf
  v_fmac_f32_dpp v19, v36, v26 quad_perm:[0,0,0,0] row_mask:0xf bank_mask:0xf
  v_fmac_f32_dpp v19, v37, v26 quad_perm:[1,1,1,1] row_mask:0xf bank_mask:0xf
  v_fmac_f32_dpp v19, v38, v26 quad_perm:[2,2,2,2] row_mask:0xf bank_mask:0xf
  v_fmac_f32_dpp v19, v39, v26 quad_perm:[3,3,3,3] row_mask:0xf bank_mask:0xf
  v_fmac_f32_dpp v19, v40, v27 quad_perm:[0,0,0,0] row_mask:0xf bank_mask:0xf
  v_fmac_f32_dpp v19, v41, v27 quad_perm:[1,1,1,1] row_mask:0xf bank_mask:0xf
  v_fmac_f32_dpp v19, v42, v27 quad_perm:[2,2,2,2] row_mask:0xf bank_mask:0xf
  v_fmac_f32_dpp v19, v43, v27 quad_perm:[3,3,3,3] row_mask:0xf bank_mask:0xf
  v_cvt_pk_bf16_f32 v19, v19, v19
  v_and_b32 v19, 0xffff0000, v19
  v_mul_f32 v19, s56, v19
  v_cvt_pk_bf16_f32 v19, v19, v19
  v_and_b32 v19, 0xffff0000, v19
  v_max_f32 v16, v16, v19
  ds_write_b32 v3, v19
  v_add_u32 v3, 256, v3
  s_waitcnt vmcnt(46)
  v_mfma_f32_16x16x32_bf16 v[28:31], v[112:115], v[4:7], 0
  v_mfma_f32_16x16x32_bf16 v[32:35], v[116:119], v[4:7], 0
  v_mfma_f32_16x16x32_bf16 v[36:39], v[120:123], v[4:7], 0
  v_mfma_f32_16x16x32_bf16 v[40:43], v[124:127], v[4:7], 0
  s_nop 4
  v_mul_f32_dpp v19, v28, v24 quad_perm:[0,0,0,0] row_mask:0xf bank_mask:0xf
  v_fmac_f32_dpp v19, v29, v24 quad_perm:[1,1,1,1] row_mask:0xf bank_mask:0xf
  v_fmac_f32_dpp v19, v30, v24 quad_perm:[2,2,2,2] row_mask:0xf bank_mask:0xf
  v_fmac_f32_dpp v19, v31, v24 quad_perm:[3,3,3,3] row_mask:0xf bank_mask:0xf
  v_fmac_f32_dpp v19, v32, v25 quad_perm:[0,0,0,0] row_mask:0xf bank_mask:0xf
  v_fmac_f32_dpp v19, v33, v25 quad_perm:[1,1,1,1] row_mask:0xf bank_mask:0xf
  v_fmac_f32_dpp v19, v34, v25 quad_perm:[2,2,2,2] row_mask:0xf bank_mask:0xf
  v_fmac_f32_dpp v19, v35, v25 quad_perm:[3,3,3,3] row_mask:0xf bank_mask:0xf
  v_fmac_f32_dpp v19, v36, v26 quad_perm:[0,0,0,0] row_mask:0xf bank_mask:0xf
  v_fmac_f32_dpp v19, v37, v26 quad_perm:[1,1,1,1] row_mask:0xf bank_mask:0xf
  v_fmac_f32_dpp v19, v38, v26 quad_perm:[2,2,2,2] row_mask:0xf bank_mask:0xf
  v_fmac_f32_dpp v19, v39, v26 quad_perm:[3,3,3,3] row_mask:0xf bank_mask:0xf
  v_fmac_f32_dpp v19, v40, v27 quad_perm:[0,0,0,0] row_mask:0xf bank_mask:0xf
  v_fmac_f32_dpp v19, v41, v27 quad_perm:[1,1,1,1] row_mask:0xf bank_mask:0xf
  v_fmac_f32_dpp v19, v42, v27 quad_perm:[2,2,2,2] row_mask:0xf bank_mask:0xf
  v_fmac_f32_dpp v19, v43, v27 quad_perm:[3,3,3,3] row_mask:0xf bank_mask:0xf
  v_cvt_pk_bf16_f32 v19, v19, v19
  v_and_b32 v19, 0xffff0000, v19
  v_mul_f32 v19, s56, v19
  v_cvt_pk_bf16_f32 v19, v19, v19
  v_and_b32 v19, 0xffff0000, v19
  v_max_f32 v16, v16, v19
  ds_write_b32 v3, v19
  v_add_u32 v3, 256, v3
  s_waitcnt vmcnt(42)
  v_mfma_f32_16x16x32_bf16 v[28:31], v[128:131], v[4:7], 0
  v_mfma_f32_16x16x32_bf16 v[32:35], v[132:135], v[4:7], 0
  v_mfma_f32_16x16x32_bf16 v[36:39], v[136:139], v[4:7], 0
  v_mfma_f32_16x16x32_bf16 v[40:43], v[140:143], v[4:7], 0
  s_nop 4
  v_mul_f32_dpp v19, v28, v24 quad_perm:[0,0,0,0] row_mask:0xf bank_mask:0xf
  v_fmac_f32_dpp v19, v29, v24 quad_perm:[1,1,1,1] row_mask:0xf bank_mask:0xf
  v_fmac_f32_dpp v19, v30, v24 quad_perm:[2,2,2,2] row_mask:0xf bank_mask:0xf
  v_fmac_f32_dpp v19, v31, v24 quad_perm:[3,3,3,3] row_mask:0xf bank_mask:0xf
  v_fmac_f32_dpp v19, v32, v25 quad_perm:[0,0,0,0] row_mask:0xf bank_mask:0xf
  v_fmac_f32_dpp v19, v33, v25 quad_perm:[1,1,1,1] row_mask:0xf bank_mask:0xf
  v_fmac_f32_dpp v19, v34, v25 quad_perm:[2,2,2,2] row_mask:0xf bank_mask:0xf
  v_fmac_f32_dpp v19, v35, v25 quad_perm:[3,3,3,3] row_mask:0xf bank_mask:0xf
  v_fmac_f32_dpp v19, v36, v26 quad_perm:[0,0,0,0] row_mask:0xf bank_mask:0xf
  v_fmac_f32_dpp v19, v37, v26 quad_perm:[1,1,1,1] row_mask:0xf bank_mask:0xf
  v_fmac_f32_dpp v19, v38, v26 quad_perm:[2,2,2,2] row_mask:0xf bank_mask:0xf
  v_fmac_f32_dpp v19, v39, v26 quad_perm:[3,3,3,3] row_mask:0xf bank_mask:0xf
  v_fmac_f32_dpp v19, v40, v27 quad_perm:[0,0,0,0] row_mask:0xf bank_mask:0xf
  v_fmac_f32_dpp v19, v41, v27 quad_perm:[1,1,1,1] row_mask:0xf bank_mask:0xf
  v_fmac_f32_dpp v19, v42, v27 quad_perm:[2,2,2,2] row_mask:0xf bank_mask:0xf
  v_fmac_f32_dpp v19, v43, v27 quad_perm:[3,3,3,3] row_mask:0xf bank_mask:0xf
  v_cvt_pk_bf16_f32 v19, v19, v19
  v_and_b32 v19, 0xffff0000, v19
  v_mul_f32 v19, s56, v19
  v_cvt_pk_bf16_f32 v19, v19, v19
  v_and_b32 v19, 0xffff0000, v19
  v_max_f32 v16, v16, v19
  ds_write_b32 v3, v19
  v_add_u32 v3, 256, v3
  s_waitcnt vmcnt(38)
  v_mfma_f32_16x16x32_bf16 v[28:31], v[144:147], v[4:7], 0
  v_mfma_f32_16x16x32_bf16 v[32:35], v[148:151], v[4:7], 0
  v_mfma_f32_16x16x32_bf16 v[36:39], v[152:155], v[4:7], 0
  v_mfma_f32_16x16x32_bf16 v[40:43], v[156:159], v[4:7], 0
  s_nop 4
  v_mul_f32_dpp v19, v28, v24 quad_perm:[0,0,0,0] row_mask:0xf bank_mask:0xf
  v_fmac_f32_dpp v19, v29, v24 quad_perm:[1,1,1,1] row_mask:0xf bank_mask:0xf
  v_fmac_f32_dpp v19, v30, v24 quad_perm:[2,2,2,2] row_mask:0xf bank_mask:0xf
  v_fmac_f32_dpp v19, v31, v24 quad_perm:[3,3,3,3] row_mask:0xf bank_mask:0xf
  v_fmac_f32_dpp v19, v32, v25 quad_perm:[0,0,0,0] row_mask:0xf bank_mask:0xf
  v_fmac_f32_dpp v19, v33, v25 quad_perm:[1,1,1,1] row_mask:0xf bank_mask:0xf
  v_fmac_f32_dpp v19, v34, v25 quad_perm:[2,2,2,2] row_mask:0xf bank_mask:0xf
  v_fmac_f32_dpp v19, v35, v25 quad_perm:[3,3,3,3] row_mask:0xf bank_mask:0xf
  v_fmac_f32_dpp v19, v36, v26 quad_perm:[0,0,0,0] row_mask:0xf bank_mask:0xf
  v_fmac_f32_dpp v19, v37, v26 quad_perm:[1,1,1,1] row_mask:0xf bank_mask:0xf
  v_fmac_f32_dpp v19, v38, v26 quad_perm:[2,2,2,2] row_mask:0xf bank_mask:0xf
  v_fmac_f32_dpp v19, v39, v26 quad_perm:[3,3,3,3] row_mask:0xf bank_mask:0xf
  v_fmac_f32_dpp v19, v40, v27 quad_perm:[0,0,0,0] row_mask:0xf bank_mask:0xf
  v_fmac_f32_dpp v19, v41, v27 quad_perm:[1,1,1,1] row_mask:0xf bank_mask:0xf
  v_fmac_f32_dpp v19, v42, v27 quad_perm:[2,2,2,2] row_mask:0xf bank_mask:0xf
  v_fmac_f32_dpp v19, v43, v27 quad_perm:[3,3,3,3] row_mask:0xf bank_mask:0xf
  v_cvt_pk_bf16_f32 v19, v19, v19
  v_and_b32 v19, 0xffff0000, v19
  v_mul_f32 v19, s56, v19
  v_cvt_pk_bf16_f32 v19, v19, v19
  v_and_b32 v19, 0xffff0000, v19
  v_max_f32 v16, v16, v19
  ds_write_b32 v3, v19
  v_add_u32 v3, 256, v3
  s_waitcnt vmcnt(34)
  v_mfma_f32_16x16x32_bf16 v[28:31], v[160:163], v[4:7], 0
  v_mfma_f32_16x16x32_bf16 v[32:35], v[164:167], v[4:7], 0
  v_mfma_f32_16x16x32_bf16 v[36:39], v[168:171], v[4:7], 0
  v_mfma_f32_16x16x32_bf16 v[40:43], v[172:175], v[4:7], 0
  s_nop 4
  v_mul_f32_dpp v19, v28, v24 quad_perm:[0,0,0,0] row_mask:0xf bank_mask:0xf
  v_fmac_f32_dpp v19, v29, v24 quad_perm:[1,1,1,1] row_mask:0xf bank_mask:0xf
  v_fmac_f32_dpp v19, v30, v24 quad_perm:[2,2,2,2] row_mask:0xf bank_mask:0xf
  v_fmac_f32_dpp v19, v31, v24 quad_perm:[3,3,3,3] row_mask:0xf bank_mask:0xf
  v_fmac_f32_dpp v19, v32, v25 quad_perm:[0,0,0,0] row_mask:0xf bank_mask:0xf
  v_fmac_f32_dpp v19, v33, v25 quad_perm:[1,1,1,1] row_mask:0xf bank_mask:0xf
  v_fmac_f32_dpp v19, v34, v25 quad_perm:[2,2,2,2] row_mask:0xf bank_mask:0xf
  v_fmac_f32_dpp v19, v35, v25 quad_perm:[3,3,3,3] row_mask:0xf bank_mask:0xf
  v_fmac_f32_dpp v19, v36, v26 quad_perm:[0,0,0,0] row_mask:0xf bank_mask:0xf
  v_fmac_f32_dpp v19, v37, v26 quad_perm:[1,1,1,1] row_mask:0xf bank_mask:0xf
  v_fmac_f32_dpp v19, v38, v26 quad_perm:[2,2,2,2] row_mask:0xf bank_mask:0xf
  v_fmac_f32_dpp v19, v39, v26 quad_perm:[3,3,3,3] row_mask:0xf bank_mask:0xf
  v_fmac_f32_dpp v19, v40, v27 quad_perm:[0,0,0,0] row_mask:0xf bank_mask:0xf
  v_fmac_f32_dpp v19, v41, v27 quad_perm:[1,1,1,1] row_mask:0xf bank_mask:0xf
  v_fmac_f32_dpp v19, v42, v27 quad_perm:[2,2,2,2] row_mask:0xf bank_mask:0xf
  v_fmac_f32_dpp v19, v43, v27 quad_perm:[3,3,3,3] row_mask:0xf bank_mask:0xf
  v_cvt_pk_bf16_f32 v19, v19, v19
  v_and_b32 v19, 0xffff0000, v19
  v_mul_f32 v19, s56, v19
  v_cvt_pk_bf16_f32 v19, v19, v19
  v_and_b32 v19, 0xffff0000, v19
  v_max_f32 v16, v16, v19
  ds_write_b32 v3, v19
  v_add_u32 v3, 256, v3
  s_waitcnt vmcnt(30)
  v_mfma_f32_16x16x32_bf16 v[28:31], v[176:179], v[4:7], 0
  v_mfma_f32_16x16x32_bf16 v[32:35], v[180:183], v[4:7], 0
  v_mfma_f32_16x16x32_bf16 v[36:39], v[184:187], v[4:7], 0
  v_mfma_f32_16x16x32_bf16 v[40:43], v[188:191], v[4:7], 0
  s_nop 4
  v_mul_f32_dpp v19, v28, v24 quad_perm:[0,0,0,0] row_mask:0xf bank_mask:0xf
  v_fmac_f32_dpp v19, v29, v24 quad_perm:[1,1,1,1] row_mask:0xf bank_mask:0xf
  v_fmac_f32_dpp v19, v30, v24 quad_perm:[2,2,2,2] row_mask:0xf bank_mask:0xf
  v_fmac_f32_dpp v19, v31, v24 quad_perm:[3,3,3,3] row_mask:0xf bank_mask:0xf
  v_fmac_f32_dpp v19, v32, v25 quad_perm:[0,0,0,0] row_mask:0xf bank_mask:0xf
  v_fmac_f32_dpp v19, v33, v25 quad_perm:[1,1,1,1] row_mask:0xf bank_mask:0xf
  v_fmac_f32_dpp v19, v34, v25 quad_perm:[2,2,2,2] row_mask:0xf bank_mask:0xf
  v_fmac_f32_dpp v19, v35, v25 quad_perm:[3,3,3,3] row_mask:0xf bank_mask:0xf
  v_fmac_f32_dpp v19, v36, v26 quad_perm:[0,0,0,0] row_mask:0xf bank_mask:0xf
  v_fmac_f32_dpp v19, v37, v26 quad_perm:[1,1,1,1] row_mask:0xf bank_mask:0xf
  v_fmac_f32_dpp v19, v38, v26 quad_perm:[2,2,2,2] row_mask:0xf bank_mask:0xf
  v_fmac_f32_dpp v19, v39, v26 quad_perm:[3,3,3,3] row_mask:0xf bank_mask:0xf
  v_fmac_f32_dpp v19, v40, v27 quad_perm:[0,0,0,0] row_mask:0xf bank_mask:0xf
  v_fmac_f32_dpp v19, v41, v27 quad_perm:[1,1,1,1] row_mask:0xf bank_mask:0xf
  v_fmac_f32_dpp v19, v42, v27 quad_perm:[2,2,2,2] row_mask:0xf bank_mask:0xf
  v_fmac_f32_dpp v19, v43, v27 quad_perm:[3,3,3,3] row_mask:0xf bank_mask:0xf
  v_cvt_pk_bf16_f32 v19, v19, v19
  v_and_b32 v19, 0xffff0000, v19
  v_mul_f32 v19, s56, v19
  v_cvt_pk_bf16_f32 v19, v19, v19
  v_and_b32 v19, 0xffff0000, v19
  v_max_f32 v16, v16, v19
  ds_write_b32 v3, v19
  v_add_u32 v3, 256, v3
  s_waitcnt vmcnt(26)
  v_mfma_f32_16x16x32_bf16 v[28:31], v[192:195], v[4:7], 0
  v_mfma_f32_16x16x32_bf16 v[32:35], v[196:199], v[4:7], 0
  v_mfma_f32_16x16x32_bf16 v[36:39], v[200:203], v[4:7], 0
  v_mfma_f32_16x16x32_bf16 v[40:43], v[204:207], v[4:7], 0
  s_nop 4
  v_mul_f32_dpp v19, v28, v24 quad_perm:[0,0,0,0] row_mask:0xf bank_mask:0xf
  v_fmac_f32_dpp v19, v29, v24 quad_perm:[1,1,1,1] row_mask:0xf bank_mask:0xf
  v_fmac_f32_dpp v19, v30, v24 quad_perm:[2,2,2,2] row_mask:0xf bank_mask:0xf
  v_fmac_f32_dpp v19, v31, v24 quad_perm:[3,3,3,3] row_mask:0xf bank_mask:0xf
  v_fmac_f32_dpp v19, v32, v25 quad_perm:[0,0,0,0] row_mask:0xf bank_mask:0xf
  v_fmac_f32_dpp v19, v33, v25 quad_perm:[1,1,1,1] row_mask:0xf bank_mask:0xf
  v_fmac_f32_dpp v19, v34, v25 quad_perm:[2,2,2,2] row_mask:0xf bank_mask:0xf
  v_fmac_f32_dpp v19, v35, v25 quad_perm:[3,3,3,3] row_mask:0xf bank_mask:0xf
  v_fmac_f32_dpp v19, v36, v26 quad_perm:[0,0,0,0] row_mask:0xf bank_mask:0xf
  v_fmac_f32_dpp v19, v37, v26 quad_perm:[1,1,1,1] row_mask:0xf bank_mask:0xf
  v_fmac_f32_dpp v19, v38, v26 quad_perm:[2,2,2,2] row_mask:0xf bank_mask:0xf
  v_fmac_f32_dpp v19, v39, v26 quad_perm:[3,3,3,3] row_mask:0xf bank_mask:0xf
  v_fmac_f32_dpp v19, v40, v27 quad_perm:[0,0,0,0] row_mask:0xf bank_mask:0xf
  v_fmac_f32_dpp v19, v41, v27 quad_perm:[1,1,1,1] row_mask:0xf bank_mask:0xf
  v_fmac_f32_dpp v19, v42, v27 quad_perm:[2,2,2,2] row_mask:0xf bank_mask:0xf
  v_fmac_f32_dpp v19, v43, v27 quad_perm:[3,3,3,3] row_mask:0xf bank_mask:0xf
  v_cvt_pk_bf16_f32 v19, v19, v19
  v_and_b32 v19, 0xffff0000, v19
  v_mul_f32 v19, s56, v19
  v_cvt_pk_bf16_f32 v19, v19, v19
  v_and_b32 v19, 0xffff0000, v19
  v_max_f32 v16, v16, v19
  ds_write_b32 v3, v19
  v_add_u32 v3, 256, v3
  s_waitcnt vmcnt(22)
  v_mfma_f32_16x16x32_bf16 v[28:31], v[208:211], v[4:7], 0
  v_mfma_f32_16x16x32_bf16 v[32:35], v[212:215], v[4:7], 0
  v_mfma_f32_16x16x32_bf16 v[36:39], v[216:219], v[4:7], 0
  v_mfma_f32_16x16x32_bf16 v[40:43], v[220:223], v[4:7], 0
  s_nop 4
  v_mul_f32_dpp v19, v28, v24 quad_perm:[0,0,0,0] row_mask:0xf bank_mask:0xf
  v_fmac_f32_dpp v19, v29, v24 quad_perm:[1,1,1,1] row_mask:0xf bank_mask:0xf
  v_fmac_f32_dpp v19, v30, v24 quad_perm:[2,2,2,2] row_mask:0xf bank_mask:0xf
  v_fmac_f32_dpp v19, v31, v24 quad_perm:[3,3,3,3] row_mask:0xf bank_mask:0xf
  v_fmac_f32_dpp v19, v32, v25 quad_perm:[0,0,0,0] row_mask:0xf bank_mask:0xf
  v_fmac_f32_dpp v19, v33, v25 quad_perm:[1,1,1,1] row_mask:0xf bank_mask:0xf
  v_fmac_f32_dpp v19, v34, v25 quad_perm:[2,2,2,2] row_mask:0xf bank_mask:0xf
  v_fmac_f32_dpp v19, v35, v25 quad_perm:[3,3,3,3] row_mask:0xf bank_mask:0xf
  v_fmac_f32_dpp v19, v36, v26 quad_perm:[0,0,0,0] row_mask:0xf bank_mask:0xf
  v_fmac_f32_dpp v19, v37, v26 quad_perm:[1,1,1,1] row_mask:0xf bank_mask:0xf
  v_fmac_f32_dpp v19, v38, v26 quad_perm:[2,2,2,2] row_mask:0xf bank_mask:0xf
  v_fmac_f32_dpp v19, v39, v26 quad_perm:[3,3,3,3] row_mask:0xf bank_mask:0xf
  v_fmac_f32_dpp v19, v40, v27 quad_perm:[0,0,0,0] row_mask:0xf bank_mask:0xf
  v_fmac_f32_dpp v19, v41, v27 quad_perm:[1,1,1,1] row_mask:0xf bank_mask:0xf
  v_fmac_f32_dpp v19, v42, v27 quad_perm:[2,2,2,2] row_mask:0xf bank_mask:0xf
  v_fmac_f32_dpp v19, v43, v27 quad_perm:[3,3,3,3] row_mask:0xf bank_mask:0xf
  v_cvt_pk_bf16_f32 v19, v19, v19
  v_and_b32 v19, 0xffff0000, v19
  v_mul_f32 v19, s56, v19
  v_cvt_pk_bf16_f32 v19, v19, v19
  v_and_b32 v19, 0xffff0000, v19
  v_max_f32 v16, v16, v19
  ds_write_b32 v3, v19
  v_add_u32 v3, 256, v3
  s_waitcnt vmcnt(18)
  v_mfma_f32_16x16x32_bf16 v[28:31], v[224:227], v[4:7], 0
  v_mfma_f32_16x16x32_bf16 v[32:35], v[228:231], v[4:7], 0
  v_mfma_f32_16x16x32_bf16 v[36:39], v[232:235], v[4:7], 0
  v_mfma_f32_16x16x32_bf16 v[40:43], v[236:239], v[4:7], 0
  s_nop 4
  v_mul_f32_dpp v19, v28, v24 quad_perm:[0,0,0,0] row_mask:0xf bank_mask:0xf
  v_fmac_f32_dpp v19, v29, v24 quad_perm:[1,1,1,1] row_mask:0xf bank_mask:0xf
  v_fmac_f32_dpp v19, v30, v24 quad_perm:[2,2,2,2] row_mask:0xf bank_mask:0xf
  v_fmac_f32_dpp v19, v31, v24 quad_perm:[3,3,3,3] row_mask:0xf bank_mask:0xf
  v_fmac_f32_dpp v19, v32, v25 quad_perm:[0,0,0,0] row_mask:0xf bank_mask:0xf
  v_fmac_f32_dpp v19, v33, v25 quad_perm:[1,1,1,1] row_mask:0xf bank_mask:0xf
  v_fmac_f32_dpp v19, v34, v25 quad_perm:[2,2,2,2] row_mask:0xf bank_mask:0xf
  v_fmac_f32_dpp v19, v35, v25 quad_perm:[3,3,3,3] row_mask:0xf bank_mask:0xf
  v_fmac_f32_dpp v19, v36, v26 quad_perm:[0,0,0,0] row_mask:0xf bank_mask:0xf
  v_fmac_f32_dpp v19, v37, v26 quad_perm:[1,1,1,1] row_mask:0xf bank_mask:0xf
  v_fmac_f32_dpp v19, v38, v26 quad_perm:[2,2,2,2] row_mask:0xf bank_mask:0xf
  v_fmac_f32_dpp v19, v39, v26 quad_perm:[3,3,3,3] row_mask:0xf bank_mask:0xf
  v_fmac_f32_dpp v19, v40, v27 quad_perm:[0,0,0,0] row_mask:0xf bank_mask:0xf
  v_fmac_f32_dpp v19, v41, v27 quad_perm:[1,1,1,1] row_mask:0xf bank_mask:0xf
  v_fmac_f32_dpp v19, v42, v27 quad_perm:[2,2,2,2] row_mask:0xf bank_mask:0xf
  v_fmac_f32_dpp v19, v43, v27 quad_perm:[3,3,3,3] row_mask:0xf bank_mask:0xf
  v_cvt_pk_bf16_f32 v19, v19, v19
  v_and_b32 v19, 0xffff0000, v19
  v_mul_f32 v19, s56, v19
  v_cvt_pk_bf16_f32 v19, v19, v19
  v_and_b32 v19, 0xffff0000, v19
  v_max_f32 v16, v16, v19
  ds_write_b32 v3, v19
  v_add_u32 v3, 256, v3
  s_waitcnt vmcnt(14)
  v_mfma_f32_16x16x32_bf16 v[28:31], v[240:243], v[4:7], 0
  v_mfma_f32_16x16x32_bf16 v[32:35], v[244:247], v[4:7], 0
  v_mfma_f32_16x16x32_bf16 v[36:39], v[248:251], v[4:7], 0
  v_mfma_f32_16x16x32_bf16 v[40:43], v[252:255], v[4:7], 0
  s_nop 4
  v_mul_f32_dpp v19, v28, v24 quad_perm:[0,0,0,0] row_mask:0xf bank_mask:0xf
  v_fmac_f32_dpp v19, v29, v24 quad_perm:[1,1,1,1] row_mask:0xf bank_mask:0xf
  v_fmac_f32_dpp v19, v30, v24 quad_perm:[2,2,2,2] row_mask:0xf bank_mask:0xf
  v_fmac_f32_dpp v19, v31, v24 quad_perm:[3,3,3,3] row_mask:0xf bank_mask:0xf
  v_fmac_f32_dpp v19, v32, v25 quad_perm:[0,0,0,0] row_mask:0xf bank_mask:0xf
  v_fmac_f32_dpp v19, v33, v25 quad_perm:[1,1,1,1] row_mask:0xf bank_mask:0xf
  v_fmac_f32_dpp v19, v34, v25 quad_perm:[2,2,2,2] row_mask:0xf bank_mask:0xf
  v_fmac_f32_dpp v19, v35, v25 quad_perm:[3,3,3,3] row_mask:0xf bank_mask:0xf
  v_fmac_f32_dpp v19, v36, v26 quad_perm:[0,0,0,0] row_mask:0xf bank_mask:0xf
  v_fmac_f32_dpp v19, v37, v26 quad_perm:[1,1,1,1] row_mask:0xf bank_mask:0xf
  v_fmac_f32_dpp v19, v38, v26 quad_perm:[2,2,2,2] row_mask:0xf bank_mask:0xf
  v_fmac_f32_dpp v19, v39, v26 quad_perm:[3,3,3,3] row_mask:0xf bank_mask:0xf
  v_fmac_f32_dpp v19, v40, v27 quad_perm:[0,0,0,0] row_mask:0xf bank_mask:0xf
  v_fmac_f32_dpp v19, v41, v27 quad_perm:[1,1,1,1] row_mask:0xf bank_mask:0xf
  v_fmac_f32_dpp v19, v42, v27 quad_perm:[2,2,2,2] row_mask:0xf bank_mask:0xf
  v_fmac_f32_dpp v19, v43, v27 quad_perm:[3,3,3,3] row_mask:0xf bank_mask:0xf
  v_cvt_pk_bf16_f32 v19, v19, v19
  v_and_b32 v19, 0xffff0000, v19
  v_mul_f32 v19, s56, v19
  v_cvt_pk_bf16_f32 v19, v19, v19
  v_and_b32 v19, 0xffff0000, v19
  v_max_f32 v16, v16, v19
  ds_write_b32 v3, v19
  v_add_u32 v3, 256, v3
  s_waitcnt vmcnt(10)
  v_add_u32 v63, 91136, v62
  ds_read_b128 v[128:131], v63 offset:0
  ds_read_b128 v[132:135], v63 offset:1024
  ds_read_b128 v[136:139], v63 offset:2048
  ds_read_b128 v[140:143], v63 offset:3072
  s_waitcnt lgkmcnt(0)
  v_mfma_f32_16x16x32_bf16 v[28:31], v[128:131], v[4:7], 0
  v_mfma_f32_16x16x32_bf16 v[32:35], v[132:135], v[4:7], 0
  v_mfma_f32_16x16x32_bf16 v[36:39], v[136:139], v[4:7], 0
  v_mfma_f32_16x16x32_bf16 v[40:43], v[140:143], v[4:7], 0
  s_nop 4
  v_mul_f32_dpp v19, v28, v24 quad_perm:[0,0,0,0] row_mask:0xf bank_mask:0xf
  v_fmac_f32_dpp v19, v29, v24 quad_perm:[1,1,1,1] row_mask:0xf bank_mask:0xf
  v_fmac_f32_dpp v19, v30, v24 quad_perm:[2,2,2,2] row_mask:0xf bank_mask:0xf
  v_fmac_f32_dpp v19, v31, v24 quad_perm:[3,3,3,3] row_mask:0xf bank_mask:0xf
  v_fmac_f32_dpp v19, v32, v25 quad_perm:[0,0,0,0] row_mask:0xf bank_mask:0xf
  v_fmac_f32_dpp v19, v33, v25 quad_perm:[1,1,1,1] row_mask:0xf bank_mask:0xf
  v_fmac_f32_dpp v19, v34, v25 quad_perm:[2,2,2,2] row_mask:0xf bank_mask:0xf
  v_fmac_f32_dpp v19, v35, v25 quad_perm:[3,3,3,3] row_mask:0xf bank_mask:0xf
  v_fmac_f32_dpp v19, v36, v26 quad_perm:[0,0,0,0] row_mask:0xf bank_mask:0xf
  v_fmac_f32_dpp v19, v37, v26 quad_perm:[1,1,1,1] row_mask:0xf bank_mask:0xf
  v_fmac_f32_dpp v19, v38, v26 quad_perm:[2,2,2,2] row_mask:0xf bank_mask:0xf
  v_fmac_f32_dpp v19, v39, v26 quad_perm:[3,3,3,3] row_mask:0xf bank_mask:0xf
  v_fmac_f32_dpp v19, v40, v27 quad_perm:[0,0,0,0] row_mask:0xf bank_mask:0xf
  v_fmac_f32_dpp v19, v41, v27 quad_perm:[1,1,1,1] row_mask:0xf bank_mask:0xf
  v_fmac_f32_dpp v19, v42, v27 quad_perm:[2,2,2,2] row_mask:0xf bank_mask:0xf
  v_fmac_f32_dpp v19, v43, v27 quad_perm:[3,3,3,3] row_mask:0xf bank_mask:0xf
  v_cvt_pk_bf16_f32 v19, v19, v19
  v_and_b32 v19, 0xffff0000, v19
  v_mul_f32 v19, s56, v19
  v_cvt_pk_bf16_f32 v19, v19, v19
  v_and_b32 v19, 0xffff0000, v19
  v_max_f32 v16, v16, v19
  ds_write_b32 v3, v19
  v_add_u32 v3, 256, v3
  s_waitcnt vmcnt(6)
  v_add_u32 v63, 144384, v62
  ds_read_b128 v[128:131], v63 offset:0
  ds_read_b128 v[132:135], v63 offset:1024
  ds_read_b128 v[136:139], v63 offset:2048
  ds_read_b128 v[140:143], v63 offset:3072
  s_waitcnt lgkmcnt(0)
  v_mfma_f32_16x16x32_bf16 v[28:31], v[128:131], v[4:7], 0
  v_mfma_f32_16x16x32_bf16 v[32:35], v[132:135], v[4:7], 0
  v_mfma_f32_16x16x32_bf16 v[36:39], v[136:139], v[4:7], 0
  v_mfma_f32_16x16x32_bf16 v[40:43], v[140:143], v[4:7], 0
  s_nop 4
  v_mul_f32_dpp v19, v28, v24 quad_perm:[0,0,0,0] row_mask:0xf bank_mask:0xf
  v_fmac_f32_dpp v19, v29, v24 quad_perm:[1,1,1,1] row_mask:0xf bank_mask:0xf
  v_fmac_f32_dpp v19, v30, v24 quad_perm:[2,2,2,2] row_mask:0xf bank_mask:0xf
  v_fmac_f32_dpp v19, v31, v24 quad_perm:[3,3,3,3] row_mask:0xf bank_mask:0xf
  v_fmac_f32_dpp v19, v32, v25 quad_perm:[0,0,0,0] row_mask:0xf bank_mask:0xf
  v_fmac_f32_dpp v19, v33, v25 quad_perm:[1,1,1,1] row_mask:0xf bank_mask:0xf
  v_fmac_f32_dpp v19, v34, v25 quad_perm:[2,2,2,2] row_mask:0xf bank_mask:0xf
  v_fmac_f32_dpp v19, v35, v25 quad_perm:[3,3,3,3] row_mask:0xf bank_mask:0xf
  v_fmac_f32_dpp v19, v36, v26 quad_perm:[0,0,0,0] row_mask:0xf bank_mask:0xf
  v_fmac_f32_dpp v19, v37, v26 quad_perm:[1,1,1,1] row_mask:0xf bank_mask:0xf
  v_fmac_f32_dpp v19, v38, v26 quad_perm:[2,2,2,2] row_mask:0xf bank_mask:0xf
  v_fmac_f32_dpp v19, v39, v26 quad_perm:[3,3,3,3] row_mask:0xf bank_mask:0xf
  v_fmac_f32_dpp v19, v40, v27 quad_perm:[0,0,0,0] row_mask:0xf bank_mask:0xf
  v_fmac_f32_dpp v19, v41, v27 quad_perm:[1,1,1,1] row_mask:0xf bank_mask:0xf
  v_fmac_f32_dpp v19, v42, v27 quad_perm:[2,2,2,2] row_mask:0xf bank_mask:0xf
  v_fmac_f32_dpp v19, v43, v27 quad_perm:[3,3,3,3] row_mask:0xf bank_mask:0xf
  v_cvt_pk_bf16_f32 v19, v19, v19
  v_and_b32 v19, 0xffff0000, v19
  v_mul_f32 v19, s56, v19
  v_cvt_pk_bf16_f32 v19, v19, v19
  v_and_b32 v19, 0xffff0000, v19
  v_max_f32 v16, v16, v19
  ds_write_b32 v3, v19
  v_add_u32 v3, 256, v3
  s_mov_b64 s[68:69], s[6:7]
  s_mov_b32 s70, 0x8000000
  s_mov_b32 s71, 0x20000
  s_mov_b64 s[76:77], s[6:7]
  s_mov_b32 s78, 0x8000000
  s_mov_b32 s79, 0x20000
  v_mov_b32 v62, v1
  v_mov_b32 v63, v1
  s_sub_u32 s66, 16, s72
  s_sub_u32 s75, s72, 30
  s_lshl_b32 s75, s75, 8
  s_mov_b32 s73, s55
  v_mov_b32 v53, 0
  v_mov_b32 v52, 90112
  s_lshl_b32 s58, s3, 2
  s_add_u32 s58, s58, 90144
  v_mov_b32 v61, s58
L_k0:
  s_waitcnt vmcnt(4)
  buffer_load_dwordx4 v[88:91], v62, s[68:71], s53 offen offset:2048 nt
  buffer_load_dwordx4 v[92:95], v62, s[68:71], s53 offen offset:3072 nt
  s_waitcnt vmcnt(4)
  buffer_load_dwordx4 v[96:99], v63, s[76:79], s62 offen offset:0 nt
  buffer_load_dwordx4 v[100:103], v63, s[76:79], s62 offen offset:1024 nt
  v_mfma_f32_16x16x32_bf16 v[28:31], v[64:67], v[4:7], 0
  v_mfma_f32_16x16x32_bf16 v[32:35], v[68:71], v[4:7], 0
  v_mfma_f32_16x16x32_bf16 v[36:39], v[72:75], v[4:7], 0
  v_mfma_f32_16x16x32_bf16 v[40:43], v[76:79], v[4:7], 0
  s_mov_b32 s53, s62
  s_mov_b64 s[68:69], s[76:77]
  v_mov_b32 v62, v63
  s_add_u32 s65, s65, 65536
  s_cmp_lg_u32 s65, s73
  s_cbranch_scc1 L_kv30
  s_mov_b32 s65, s64
  s_mov_b32 s73, s74
  s_mov_b32 s74, s64
  s_cmp_lg_u32 s65, s73
  s_cbranch_scc1 L_kv30
  s_mov_b64 s[76:77], s[8:9]
  v_mov_b32 v63, v2
L_kv30:
  s_mov_b32 s62, s65
  v_mul_f32_dpp v19, v28, v24 quad_perm:[0,0,0,0] row_mask:0xf bank_mask:0xf
  v_fmac_f32_dpp v19, v29, v24 quad_perm:[1,1,1,1] row_mask:0xf bank_mask:0xf
  v_fmac_f32_dpp v19, v30, v24 quad_perm:[2,2,2,2] row_mask:0xf bank_mask:0xf
  v_fmac_f32_dpp v19, v31, v24 quad_perm:[3,3,3,3] row_mask:0xf bank_mask:0xf
  v_fmac_f32_dpp v19, v32, v25 quad_perm:[0,0,0,0] row_mask:0xf bank_mask:0xf
  v_fmac_f32_dpp v19, v33, v25 quad_perm:[1,1,1,1] row_mask:0xf bank_mask:0xf
  v_fmac_f32_dpp v19, v34, v25 quad_perm:[2,2,2,2] row_mask:0xf bank_mask:0xf
  v_fmac_f32_dpp v19, v35, v25 quad_perm:[3,3,3,3] row_mask:0xf bank_mask:0xf
  v_fmac_f32_dpp v19, v36, v26 quad_perm:[0,0,0,0] row_mask:0xf bank_mask:0xf
  v_fmac_f32_dpp v19, v37, v26 quad_perm:[1,1,1,1] row_mask:0xf bank_mask:0xf
  v_fmac_f32_dpp v19, v38, v26 quad_perm:[2,2,2,2] row_mask:0xf bank_mask:0xf
  v_fmac_f32_dpp v19, v39, v26 quad_perm:[3,3,3,3] row_mask:0xf bank_mask:0xf
  v_fmac_f32_dpp v19, v40, v27 quad_perm:[0,0,0,0] row_mask:0xf bank_mask:0xf
  v_fmac_f32_dpp v19, v41, v27 quad_perm:[1,1,1,1] row_mask:0xf bank_mask:0xf
  v_fmac_f32_dpp v19, v42, v27 quad_perm:[2,2,2,2] row_mask:0xf bank_mask:0xf
  v_fmac_f32_dpp v19, v43, v27 quad_perm:[3,3,3,3] row_mask:0xf bank_mask:0xf
  v_cvt_pk_bf16_f32 v19, v19, v19
  v_and_b32 v19, 0xffff0000, v19
  v_mul_f32 v19, s56, v19
  v_cvt_pk_bf16_f32 v19, v19, v19
  v_and_b32 v19, 0xffff0000, v19
  v_max_f32 v16, v16, v19
  ds_write_b32 v3, v19
  s_cmp_eq_u32 s66, s72
  s_cselect_b32 s58, s75, 256
  v_add_u32 v3, s58, v3
  v_add_u32 v53, 1, v53
  ds_write_b32 v61, v53
  s_sub_u32 s66, s66, 1
  s_cbranch_scc1 L_kv1
L_k1:
  s_waitcnt vmcnt(4)
  buffer_load_dwordx4 v[104:107], v62, s[68:71], s53 offen offset:2048 nt
  buffer_load_dwordx4 v[108:111], v62, s[68:71], s53 offen offset:3072 nt
  s_waitcnt vmcnt(4)
  buffer_load_dwordx4 v[112:115], v63, s[76:79], s62 offen offset:0 nt
  buffer_load_dwordx4 v[116:119], v63, s[76:79], s62 offen offset:1024 nt
  v_mfma_f32_16x16x32_bf16 v[28:31], v[80:83], v[4:7], 0
  v_mfma_f32_16x16x32_bf16 v[32:35], v[84:87], v[4:7], 0
  v_mfma_f32_16x16x32_bf16 v[36:39], v[88:91], v[4:7], 0
  v_mfma_f32_16x16x32_bf16 v[40:43], v[92:95], v[4:7], 0
  s_mov_b32 s53, s62
  s_mov_b64 s[68:69], s[76:77]
  v_mov_b32 v62, v63
  s_add_u32 s65, s65, 65536
  s_cmp_lg_u32 s65, s73
  s_cbranch_scc1 L_kv31
  s_mov_b32 s65, s64
  s_mov_b32 s73, s74
  s_mov_b32 s74, s64
  s_cmp_lg_u32 s65, s73
  s_cbranch_scc1 L_kv31
  s_mov_b64 s[76:77], s[8:9]
  v_mov_b32 v63, v2
L_kv31:
  s_mov_b32 s62, s65
  v_mul_f32_dpp v19, v28, v24 quad_perm:[0,0,0,0] row_mask:0xf bank_mask:0xf
  v_fmac_f32_dpp v19, v29, v24 quad_perm:[1,1,1,1] row_mask:0xf bank_mask:0xf
  v_fmac_f32_dpp v19, v30, v24 quad_perm:[2,2,2,2] row_mask:0xf bank_mask:0xf
  v_fmac_f32_dpp v19, v31, v24 quad_perm:[3,3,3,3] row_mask:0xf bank_mask:0xf
  v_fmac_f32_dpp v19, v32, v25 quad_perm:[0,0,0,0] row_mask:0xf bank_mask:0xf
  v_fmac_f32_dpp v19, v33, v25 quad_perm:[1,1,1,1] row_mask:0xf bank_mask:0xf
  v_fmac_f32_dpp v19, v34, v25 quad_perm:[2,2,2,2] row_mask:0xf bank_mask:0xf
  v_fmac_f32_dpp v19, v35, v25 quad_perm:[3,3,3,3] row_mask:0xf bank_mask:0xf
  v_fmac_f32_dpp v19, v36, v26 quad_perm:[0,0,0,0] row_mask:0xf bank_mask:0xf
  v_fmac_f32_dpp v19, v37, v26 quad_perm:[1,1,1,1] row_mask:0xf bank_mask:0xf
  v_fmac_f32_dpp v19, v38, v26 quad_perm:[2,2,2,2] row_mask:0xf bank_mask:0xf
  v_fmac_f32_dpp v19, v39, v26 quad_perm:[3,3,3,3] row_mask:0xf bank_mask:0xf
  v_fmac_f32_dpp v19, v40, v27 quad_perm:[0,0,0,0] row_mask:0xf bank_mask:0xf
  v_fmac_f32_dpp v19, v41, v27 quad_perm:[1,1,1,1] row_mask:0xf bank_mask:0xf
  v_fmac_f32_dpp v19, v42, v27 quad_perm:[2,2,2,2] row_mask:0xf bank_mask:0xf
  v_fmac_f32_dpp v19, v43, v27 quad_perm:[3,3,3,3] row_mask:0xf bank_mask:0xf
  v_cvt_pk_bf16_f32 v19, v19, v19
  v_and_b32 v19, 0xffff0000, v19
  v_mul_f32 v19, s56, v19
  v_cvt_pk_bf16_f32 v19, v19, v19
  v_and_b32 v19, 0xffff0000, v19
  v_max_f32 v16, v16, v19
  ds_write_b32 v3, v19
  s_cmp_eq_u32 s66, s72
  s_cselect_b32 s58, s75, 256
  v_add_u32 v3, s58, v3
  v_add_u32 v53, 1, v53
  ds_write_b32 v61, v53
  s_sub_u32 s66, s66, 1
  s_cbranch_scc1 L_kv2
L_k2:
  s_waitcnt vmcnt(4)
  buffer_load_dwordx4 v[120:123], v62, s[68:71], s53 offen offset:2048 nt
  buffer_load_dwordx4 v[124:127], v62, s[68:71], s53 offen offset:3072 nt
  s_waitcnt vmcnt(4)
  buffer_load_dwordx4 v[64:67], v63, s[76:79], s62 offen offset:0 nt
  buffer_load_dwordx4 v[68:71], v63, s[76:79], s62 offen offset:1024 nt
  v_mfma_f32_16x16x32_bf16 v[28:31], v[96:99], v[4:7], 0
  v_mfma_f32_16x16x32_bf16 v[32:35], v[100:103], v[4:7], 0
  v_mfma_f32_16x16x32_bf16 v[36:39], v[104:107], v[4:7], 0
  v_mfma_f32_16x16x32_bf16 v[40:43], v[108:111], v[4:7], 0
  s_mov_b32 s53, s62
  s_mov_b64 s[68:69], s[76:77]
  v_mov_b32 v62, v63
  s_add_u32 s65, s65, 65536
  s_cmp_lg_u32 s65, s73
  s_cbranch_scc1 L_kv32
  s_mov_b32 s65, s64
  s_mov_b32 s73, s74
  s_mov_b32 s74, s64
  s_cmp_lg_u32 s65, s73
  s_cbranch_scc1 L_kv32
  s_mov_b64 s[76:77], s[8:9]
  v_mov_b32 v63, v2
L_kv32:
  s_mov_b32 s62, s65
  v_mul_f32_dpp v19, v28, v24 quad_perm:[0,0,0,0] row_mask:0xf bank_mask:0xf
  v_fmac_f32_dpp v19, v29, v24 quad_perm:[1,1,1,1] row_mask:0xf bank_mask:0xf
  v_fmac_f32_dpp v19, v30, v24 quad_perm:[2,2,2,2] row_mask:0xf bank_mask:0xf
  v_fmac_f32_dpp v19, v31, v24 quad_perm:[3,3,3,3] row_mask:0xf bank_mask:0xf
  v_fmac_f32_dpp v19, v32, v25 quad_perm:[0,0,0,0] row_mask:0xf bank_mask:0xf
  v_fmac_f32_dpp v19, v33, v25 quad_perm:[1,1,1,1] row_mask:0xf bank_mask:0xf
  v_fmac_f32_dpp v19, v34, v25 quad_perm:[2,2,2,2] row_mask:0xf bank_mask:0xf
  v_fmac_f32_dpp v19, v35, v25 quad_perm:[3,3,3,3] row_mask:0xf bank_mask:0xf
  v_fmac_f32_dpp v19, v36, v26 quad_perm:[0,0,0,0] row_mask:0xf bank_mask:0xf
  v_fmac_f32_dpp v19, v37, v26 quad_perm:[1,1,1,1] row_mask:0xf bank_mask:0xf
  v_fmac_f32_dpp v19, v38, v26 quad_perm:[2,2,2,2] row_mask:0xf bank_mask:0xf
  v_fmac_f32_dpp v19, v39, v26 quad_perm:[3,3,3,3] row_mask:0xf bank_mask:0xf
  v_fmac_f32_dpp v19, v40, v27 quad_perm:[0,0,0,0] row_mask:0xf bank_mask:0xf
  v_fmac_f32_dpp v19, v41, v27 quad_perm:[1,1,1,1] row_mask:0xf bank_mask:0xf
  v_fmac_f32_dpp v19, v42, v27 quad_perm:[2,2,2,2] row_mask:0xf bank_mask:0xf
  v_fmac_f32_dpp v19, v43, v27 quad_perm:[3,3,3,3] row_mask:0xf bank_mask:0xf
  v_cvt_pk_bf16_f32 v19, v19, v19
  v_and_b32 v19, 0xffff0000, v19
  v_mul_f32 v19, s56, v19
  v_cvt_pk_bf16_f32 v19, v19, v19
  v_and_b32 v19, 0xffff0000, v19
  v_max_f32 v16, v16, v19
  ds_write_b32 v3, v19
  s_cmp_eq_u32 s66, s72
  s_cselect_b32 s58, s75, 256
  v_add_u32 v3, s58, v3
  v_add_u32 v53, 1, v53
  ds_write_b32 v61, v53
  s_sub_u32 s66, s66, 1
  s_cbranch_scc1 L_kv3
L_k3:
  s_waitcnt vmcnt(4)
  buffer_load_dwordx4 v[72:75], v62, s[68:71], s53 offen offset:2048 nt
  buffer_load_dwordx4 v[76:79], v62, s[68:71], s53 offen offset:3072 nt
  s_waitcnt vmcnt(4)
  buffer_load_dwordx4 v[80:83], v63, s[76:79], s62 offen offset:0 nt
  buffer_load_dwordx4 v[84:87], v63, s[76:79], s62 offen offset:1024 nt
  v_mfma_f32_16x16x32_bf16 v[28:31], v[112:115], v[4:7], 0
  v_mfma_f32_16x16x32_bf16 v[32:35], v[116:119], v[4:7], 0
  v_mfma_f32_16x16x32_bf16 v[36:39], v[120:123], v[4:7], 0
  v_mfma_f32_16x16x32_bf16 v[40:43], v[124:127], v[4:7], 0
  s_mov_b32 s53, s62
  s_mov_b64 s[68:69], s[76:77]
  v_mov_b32 v62, v63
  s_add_u32 s65, s65, 65536
  s_cmp_lg_u32 s65, s73
  s_cbranch_scc1 L_kv33
  s_mov_b32 s65, s64
  s_mov_b32 s73, s74
  s_mov_b32 s74, s64
  s_cmp_lg_u32 s65, s73
  s_cbranch_scc1 L_kv33
  s_mov_b64 s[76:77], s[8:9]
  v_mov_b32 v63, v2
L_kv33:
  s_mov_b32 s62, s65
  v_mul_f32_dpp v19, v28, v24 quad_perm:[0,0,0,0] row_mask:0xf bank_mask:0xf
  v_fmac_f32_dpp v19, v29, v24 quad_perm:[1,1,1,1] row_mask:0xf bank_mask:0xf
  v_fmac_f32_dpp v19, v30, v24 quad_perm:[2,2,2,2] row_mask:0xf bank_mask:0xf
  v_fmac_f32_dpp v19, v31, v24 quad_perm:[3,3,3,3] row_mask:0xf bank_mask:0xf
  v_fmac_f32_dpp v19, v32, v25 quad_perm:[0,0,0,0] row_mask:0xf bank_mask:0xf
  v_fmac_f32_dpp v19, v33, v25 quad_perm:[1,1,1,1] row_mask:0xf bank_mask:0xf
  v_fmac_f32_dpp v19, v34, v25 quad_perm:[2,2,2,2] row_mask:0xf bank_mask:0xf
  v_fmac_f32_dpp v19, v35, v25 quad_perm:[3,3,3,3] row_mask:0xf bank_mask:0xf
  v_fmac_f32_dpp v19, v36, v26 quad_perm:[0,0,0,0] row_mask:0xf bank_mask:0xf
  v_fmac_f32_dpp v19, v37, v26 quad_perm:[1,1,1,1] row_mask:0xf bank_mask:0xf
  v_fmac_f32_dpp v19, v38, v26 quad_perm:[2,2,2,2] row_mask:0xf bank_mask:0xf
  v_fmac_f32_dpp v19, v39, v26 quad_perm:[3,3,3,3] row_mask:0xf bank_mask:0xf
  v_fmac_f32_dpp v19, v40, v27 quad_perm:[0,0,0,0] row_mask:0xf bank_mask:0xf
  v_fmac_f32_dpp v19, v41, v27 quad_perm:[1,1,1,1] row_mask:0xf bank_mask:0xf
  v_fmac_f32_dpp v19, v42, v27 quad_perm:[2,2,2,2] row_mask:0xf bank_mask:0xf
  v_fmac_f32_dpp v19, v43, v27 quad_perm:[3,3,3,3] row_mask:0xf bank_mask:0xf
  v_cvt_pk_bf16_f32 v19, v19, v19
  v_and_b32 v19, 0xffff0000, v19
  v_mul_f32 v19, s56, v19
  v_cvt_pk_bf16_f32 v19, v19, v19
  v_and_b32 v19, 0xffff0000, v19
  v_max_f32 v16, v16, v19
  ds_write_b32 v3, v19
  s_cmp_eq_u32 s66, s72
  s_cselect_b32 s58, s75, 256
  v_add_u32 v3, s58, v3
  v_add_u32 v53, 1, v53
  ds_write_b32 v61, v53
  s_sub_u32 s66, s66, 1
  s_cbranch_scc0 L_k0
L_kv0:
  v_max_f32_dpp v20, v16, v16 quad_perm:[1,0,3,2] row_mask:0xf bank_mask:0xf
  s_nop 1
  v_max_f32_dpp v20, v20, v20 quad_perm:[2,3,0,1] row_mask:0xf bank_mask:0xf
  v_mov_b32 v21, v20
  s_nop 1
  v_permlane16_swap_b32 v20, v21
  v_max_f32 v20, v20, v21
  v_mov_b32 v21, v20
  s_nop 1
  v_permlane32_swap_b32 v20, v21
  v_max_f32 v16, v20, v21
  v_lshlrev_b32 v3, 2, v0
  v_add_u32 v3, s63, v3
  ds_read_b32 v62, v3
  s_branch L_v0
L_kv1:
  v_max_f32_dpp v20, v16, v16 quad_perm:[1,0,3,2] row_mask:0xf bank_mask:0xf
  s_nop 1
  v_max_f32_dpp v20, v20, v20 quad_perm:[2,3,0,1] row_mask:0xf bank_mask:0xf
  v_mov_b32 v21, v20
  s_nop 1
  v_permlane16_swap_b32 v20, v21
  v_max_f32 v20, v20, v21
  v_mov_b32 v21, v20
  s_nop 1
  v_permlane32_swap_b32 v20, v21
  v_max_f32 v16, v20, v21
  v_lshlrev_b32 v3, 2, v0
  v_add_u32 v3, s63, v3
  ds_read_b32 v62, v3
  s_branch L_v1
L_kv2:
  v_max_f32_dpp v20, v16, v16 quad_perm:[1,0,3,2] row_mask:0xf bank_mask:0xf
  s_nop 1
  v_max_f32_dpp v20, v20, v20 quad_perm:[2,3,0,1] row_mask:0xf bank_mask:0xf
  v_mov_b32 v21, v20
  s_nop 1
  v_permlane16_swap_b32 v20, v21
  v_max_f32 v20, v20, v21
  v_mov_b32 v21, v20
  s_nop 1
  v_permlane32_swap_b32 v20, v21
  v_max_f32 v16, v20, v21
  v_lshlrev_b32 v3, 2, v0
  v_add_u32 v3, s63, v3
  ds_read_b32 v62, v3
  s_branch L_v2
L_kv3:
  v_max_f32_dpp v20, v16, v16 quad_perm:[1,0,3,2] row_mask:0xf bank_mask:0xf
  s_nop 1
  v_max_f32_dpp v20, v20, v20 quad_perm:[2,3,0,1] row_mask:0xf bank_mask:0xf
  v_mov_b32 v21, v20
  s_nop 1
  v_permlane16_swap_b32 v20, v21
  v_max_f32 v20, v20, v21
  v_mov_b32 v21, v20
  s_nop 1
  v_permlane32_swap_b32 v20, v21
  v_max_f32 v16, v20, v21
  v_lshlrev_b32 v3, 2, v0
  v_add_u32 v3, s63, v3
  ds_read_b32 v62, v3
  s_branch L_v3
L_v0:
  s_cmp_ge_u32 s65, s55
  s_cbranch_scc1 L_fin0
  s_waitcnt vmcnt(4)
  buffer_load_dwordx4 v[88:91], v2, s[36:39], s53 offen offset:2048 nt
  buffer_load_dwordx4 v[92:95], v2, s[36:39], s53 offen offset:3072 nt
  s_waitcnt lgkmcnt(0)
  v_sub_f32 v19, v62, v16
  v_mul_f32 v19, s57, v19
  v_exp_f32 v19, v19
  s_nop 0
  v_add_f32 v18, v18, v19
  v_cvt_pk_bf16_f32 v19, v19, v19
  s_nop 1
  v_and_b32_dpp v44, v19, v22 quad_perm:[0,0,0,0] row_mask:0xf bank_mask:0xf
  v_and_b32_dpp v45, v19, v23 quad_perm:[0,0,0,0] row_mask:0xf bank_mask:0xf
  v_and_b32_dpp v46, v19, v22 quad_perm:[1,1,1,1] row_mask:0xf bank_mask:0xf
  v_and_b32_dpp v47, v19, v23 quad_perm:[1,1,1,1] row_mask:0xf bank_mask:0xf
  v_and_b32_dpp v48, v19, v22 quad_perm:[2,2,2,2] row_mask:0xf bank_mask:0xf
  v_and_b32_dpp v49, v19, v23 quad_perm:[2,2,2,2] row_mask:0xf bank_mask:0xf
  v_and_b32_dpp v50, v19, v22 quad_perm:[3,3,3,3] row_mask:0xf bank_mask:0xf
  v_and_b32_dpp v51, v19, v23 quad_perm:[3,3,3,3] row_mask:0xf bank_mask:0xf
  v_add_u32 v3, 256, v3
  ds_read_b32 v62, v3
  v_add_u32 v53, 1, v53
  ds_write_b32 v61, v53
  s_waitcnt vmcnt(4)
  buffer_load_dwordx4 v[96:99], v2, s[36:39], s62 offen offset:0 nt
  buffer_load_dwordx4 v[100:103], v2, s[36:39], s62 offen offset:1024 nt
  v_mfma_f32_16x16x16_bf16 v[8:11], v[64:65], v[44:45], v[8:11]
  v_mfma_f32_16x16x16_bf16 v[12:15], v[66:67], v[44:45], v[12:15]
  v_mfma_f32_16x16x16_bf16 v[8:11], v[68:69], v[46:47], v[8:11]
  v_mfma_f32_16x16x16_bf16 v[12:15], v[70:71], v[46:47], v[12:15]
  v_mfma_f32_16x16x16_bf16 v[8:11], v[72:73], v[48:49], v[8:11]
  v_mfma_f32_16x16x16_bf16 v[12:15], v[74:75], v[48:49], v[12:15]
  v_mfma_f32_16x16x16_bf16 v[8:11], v[76:77], v[50:51], v[8:11]
  v_mfma_f32_16x16x16_bf16 v[12:15], v[78:79], v[50:51], v[12:15]
  s_mov_b32 s53, s62
  s_add_u32 s65, s65, 65536
  s_mov_b32 s62, s65
L_v1:
  s_waitcnt vmcnt(4)
  buffer_load_dwordx4 v[104:107], v2, s[36:39], s53 offen offset:2048 nt
  buffer_load_dwordx4 v[108:111], v2, s[36:39], s53 offen offset:3072 nt
  s_waitcnt lgkmcnt(0)
  v_sub_f32 v19, v62, v16
  v_mul_f32 v19, s57, v19
  v_exp_f32 v19, v19
  s_nop 0
  v_add_f32 v18, v18, v19
  v_cvt_pk_bf16_f32 v19, v19, v19
  s_nop 1
  v_and_b32_dpp v44, v19, v22 quad_perm:[0,0,0,0] row_mask:0xf bank_mask:0xf
  v_and_b32_dpp v45, v19, v23 quad_perm:[0,0,0,0] row_mask:0xf bank_mask:0xf
  v_and_b32_dpp v46, v19, v22 quad_perm:[1,1,1,1] row_mask:0xf bank_mask:0xf
  v_and_b32_dpp v47, v19, v23 quad_perm:[1,1,1,1] row_mask:0xf bank_mask:0xf
  v_and_b32_dpp v48, v19, v22 quad_perm:[2,2,2,2] row_mask:0xf bank_mask:0xf
  v_and_b32_dpp v49, v19, v23 quad_perm:[2,2,2,2] row_mask:0xf bank_mask:0xf
  v_and_b32_dpp v50, v19, v22 quad_perm:[3,3,3,3] row_mask:0xf bank_mask:0xf
  v_and_b32_dpp v51, v19, v23 quad_perm:[3,3,3,3] row_mask:0xf bank_mask:0xf
  v_add_u32 v3, 256, v3
  ds_read_b32 v62, v3
  v_add_u32 v53, 1, v53
  ds_write_b32 v61, v53
  s_waitcnt vmcnt(4)
  buffer_load_dwordx4 v[112:115], v2, s[36:39], s62 offen offset:0 nt
  buffer_load_dwordx4 v[116:119], v2, s[36:39], s62 offen offset:1024 nt
  v_mfma_f32_16x16x16_bf16 v[8:11], v[80:81], v[44:45], v[8:11]
  v_mfma_f32_16x16x16_bf16 v[12:15], v[82:83], v[44:45], v[12:15]
  v_mfma_f32_16x16x16_bf16 v[8:11], v[84:85], v[46:47], v[8:11]
  v_mfma_f32_16x16x16_bf16 v[12:15], v[86:87], v[46:47], v[12:15]
  v_mfma_f32_16x16x16_bf16 v[8:11], v[88:89], v[48:49], v[8:11]
  v_mfma_f32_16x16x16_bf16 v[12:15], v[90:91], v[48:49], v[12:15]
  v_mfma_f32_16x16x16_bf16 v[8:11], v[92:93], v[50:51], v[8:11]
  v_mfma_f32_16x16x16_bf16 v[12:15], v[94:95], v[50:51], v[12:15]
  s_mov_b32 s53, s62
  s_add_u32 s65, s65, 65536
  s_mov_b32 s62, s65
L_v2:
  s_cmp_ge_u32 s65, s55
  s_cbranch_scc1 L_fin1
  s_waitcnt vmcnt(4)
  buffer_load_dwordx4 v[120:123], v2, s[36:39], s53 offen offset:2048 nt
  buffer_load_dwordx4 v[124:127], v2, s[36:39], s53 offen offset:3072 nt
  s_waitcnt lgkmcnt(0)
  v_sub_f32 v19, v62, v16
  v_mul_f32 v19, s57, v19
  v_exp_f32 v19, v19
  s_nop 0
  v_add_f32 v18, v18, v19
  v_cvt_pk_bf16_f32 v19, v19, v19
  s_nop 1
  v_and_b32_dpp v44, v19, v22 quad_perm:[0,0,0,0] row_mask:0xf bank_mask:0xf
  v_and_b32_dpp v45, v19, v23 quad_perm:[0,0,0,0] row_mask:0xf bank_mask:0xf
  v_and_b32_dpp v46, v19, v22 quad_perm:[1,1,1,1] row_mask:0xf bank_mask:0xf
  v_and_b32_dpp v47, v19, v23 quad_perm:[1,1,1,1] row_mask:0xf bank_mask:0xf
  v_and_b32_dpp v48, v19, v22 quad_perm:[2,2,2,2] row_mask:0xf bank_mask:0xf
  v_and_b32_dpp v49, v19, v23 quad_perm:[2,2,2,2] row_mask:0xf bank_mask:0xf
  v_and_b32_dpp v50, v19, v22 quad_perm:[3,3,3,3] row_mask:0xf bank_mask:0xf
  v_and_b32_dpp v51, v19, v23 quad_perm:[3,3,3,3] row_mask:0xf bank_mask:0xf
  v_add_u32 v3, 256, v3
  ds_read_b32 v62, v3
  v_add_u32 v53, 1, v53
  ds_write_b32 v61, v53
  s_waitcnt vmcnt(4)
  buffer_load_dwordx4 v[64:67], v2, s[36:39], s62 offen offset:0 nt
  buffer_load_dwordx4 v[68:71], v2, s[36:39], s62 offen offset:1024 nt
  v_mfma_f32_16x16x16_bf16 v[8:11], v[96:97], v[44:45], v[8:11]
  v_mfma_f32_16x16x16_bf16 v[12:15], v[98:99], v[44:45], v[12:15]
  v_mfma_f32_16x16x16_bf16 v[8:11], v[100:101], v[46:47], v[8:11]
  v_mfma_f32_16x16x16_bf16 v[12:15], v[102:103], v[46:47], v[12:15]
  v_mfma_f32_16x16x16_bf16 v[8:11], v[104:105], v[48:49], v[8:11]
  v_mfma_f32_16x16x16_bf16 v[12:15], v[106:107], v[48:49], v[12:15]
  v_mfma_f32_16x16x16_bf16 v[8:11], v[108:109], v[50:51], v[8:11]
  v_mfma_f32_16x16x16_bf16 v[12:15], v[110:111], v[50:51], v[12:15]
  s_mov_b32 s53, s62
  s_add_u32 s65, s65, 65536
  s_mov_b32 s62, s65
L_v3:
  s_waitcnt vmcnt(4)
  buffer_load_dwordx4 v[72:75], v2, s[36:39], s53 offen offset:2048 nt
  buffer_load_dwordx4 v[76:79], v2, s[36:39], s53 offen offset:3072 nt
  s_waitcnt lgkmcnt(0)
  v_sub_f32 v19, v62, v16
  v_mul_f32 v19, s57, v19
  v_exp_f32 v19, v19
  s_nop 0
  v_add_f32 v18, v18, v19
  v_cvt_pk_bf16_f32 v19, v19, v19
  s_nop 1
  v_and_b32_dpp v44, v19, v22 quad_perm:[0,0,0,0] row_mask:0xf bank_mask:0xf
  v_and_b32_dpp v45, v19, v23 quad_perm:[0,0,0,0] row_mask:0xf bank_mask:0xf
  v_and_b32_dpp v46, v19, v22 quad_perm:[1,1,1,1] row_mask:0xf bank_mask:0xf
  v_and_b32_dpp v47, v19, v23 quad_perm:[1,1,1,1] row_mask:0xf bank_mask:0xf
  v_and_b32_dpp v48, v19, v22 quad_perm:[2,2,2,2] row_mask:0xf bank_mask:0xf
  v_and_b32_dpp v49, v19, v23 quad_perm:[2,2,2,2] row_mask:0xf bank_mask:0xf
  v_and_b32_dpp v50, v19, v22 quad_perm:[3,3,3,3] row_mask:0xf bank_mask:0xf
  v_and_b32_dpp v51, v19, v23 quad_perm:[3,3,3,3] row_mask:0xf bank_mask:0xf
  v_add_u32 v3, 256, v3
  ds_read_b32 v62, v3
  v_add_u32 v53, 1, v53
  ds_write_b32 v61, v53
  s_waitcnt vmcnt(4)
  buffer_load_dwordx4 v[80:83], v2, s[36:39], s62 offen offset:0 nt
  buffer_load_dwordx4 v[84:87], v2, s[36:39], s62 offen offset:1024 nt
  v_mfma_f32_16x16x16_bf16 v[8:11], v[112:113], v[44:45], v[8:11]
  v_mfma_f32_16x16x16_bf16 v[12:15], v[114:115], v[44:45], v[12:15]
  v_mfma_f32_16x16x16_bf16 v[8:11], v[116:117], v[46:47], v[8:11]
  v_mfma_f32_16x16x16_bf16 v[12:15], v[118:119], v[46:47], v[12:15]
  v_mfma_f32_16x16x16_bf16 v[8:11], v[120:121], v[48:49], v[8:11]
  v_mfma_f32_16x16x16_bf16 v[12:15], v[122:123], v[48:49], v[12:15]
  v_mfma_f32_16x16x16_bf16 v[8:11], v[124:125], v[50:51], v[8:11]
  v_mfma_f32_16x16x16_bf16 v[12:15], v[126:127], v[50:51], v[12:15]
  s_mov_b32 s53, s62
  s_add_u32 s65, s65, 65536
  s_mov_b32 s62, s65
  s_branch L_v0
L_fin0:
  buffer_load_dwordx4 v[88:91], v2, s[36:39], s53 offen offset:2048 nt
  buffer_load_dwordx4 v[92:95], v2, s[36:39], s53 offen offset:3072 nt
  s_waitcnt lgkmcnt(0)
  v_sub_f32 v19, v62, v16
  v_mul_f32 v19, s57, v19
  v_exp_f32 v19, v19
  s_nop 0
  v_add_f32 v18, v18, v19
  v_cvt_pk_bf16_f32 v19, v19, v19
  s_nop 1
  v_and_b32_dpp v44, v19, v22 quad_perm:[0,0,0,0] row_mask:0xf bank_mask:0xf
  v_and_b32_dpp v45, v19, v23 quad_perm:[0,0,0,0] row_mask:0xf bank_mask:0xf
  v_and_b32_dpp v46, v19, v22 quad_perm:[1,1,1,1] row_mask:0xf bank_mask:0xf
  v_and_b32_dpp v47, v19, v23 quad_perm:[1,1,1,1] row_mask:0xf bank_mask:0xf
  v_and_b32_dpp v48, v19, v22 quad_perm:[2,2,2,2] row_mask:0xf bank_mask:0xf
  v_and_b32_dpp v49, v19, v23 quad_perm:[2,2,2,2] row_mask:0xf bank_mask:0xf
  v_and_b32_dpp v50, v19, v22 quad_perm:[3,3,3,3] row_mask:0xf bank_mask:0xf
  v_and_b32_dpp v51, v19, v23 quad_perm:[3,3,3,3] row_mask:0xf bank_mask:0xf
  v_add_u32 v3, 256, v3
  ds_read_b32 v62, v3
  s_mov_b32 s60, 16777216
L_bq34:
  ds_read_b64 v[20:21], v52
  s_waitcnt lgkmcnt(0)
  v_readfirstlane_b32 s66, v20
  v_readfirstlane_b32 s55, v21
  s_sub_u32 s60, s60, 1
  s_cbranch_scc1 L_bqd35
  s_cmp_eq_u32 s55, 0
  s_cbranch_scc1 L_bq34
L_bqd35:
  s_and_b32 s55, s55, 0xffff
  s_add_u32 s66, s66, s3
  s_lshr_b32 s58, s66, 2
  s_and_b32 s59, s58, 63
  v_readlane_b32 s60, v54, s59
  v_readlane_b32 s61, v55, s59
  s_cmp_lt_u32 s58, 64
  s_cselect_b32 s60, s60, s61
  s_and_b32 s58, s66, 3
  s_lshl_b32 s58, s58, 12
  s_add_u32 s60, s60, s58
  s_cmp_lt_u32 s66, s55
  s_cselect_b32 s53, s60, 0x8000000
  s_add_u32 s66, s66, 4
  buffer_load_dwordx4 v[96:99], v1, s[32:35], s53 offen offset:0 nt
  buffer_load_dwordx4 v[100:103], v1, s[32:35], s53 offen offset:1024 nt
  buffer_load_dwordx4 v[104:107], v1, s[32:35], s53 offen offset:2048 nt
  buffer_load_dwordx4 v[108:111], v1, s[32:35], s53 offen offset:3072 nt
  s_cmp_lt_u32 s53, 0x8000000
  s_cbranch_scc1 L_ll36
  v_mov_b32 v53, 0x10000
  ds_write_b32 v61, v53
L_ll36:
  s_lshr_b32 s58, s66, 2
  s_and_b32 s59, s58, 63
  v_readlane_b32 s60, v54, s59
  v_readlane_b32 s61, v55, s59
  s_cmp_lt_u32 s58, 64
  s_cselect_b32 s60, s60, s61
  s_and_b32 s58, s66, 3
  s_lshl_b32 s58, s58, 12
  s_add_u32 s60, s60, s58
  s_cmp_lt_u32 s66, s55
  s_cselect_b32 s62, s60, 0x8000000
  s_add_u32 s66, s66, 4
  s_waitcnt vmcnt(10)
  buffer_load_dwordx4 v[112:115], v2, s[36:39], s53 offen offset:0 nt
  buffer_load_dwordx4 v[116:119], v2, s[36:39], s53 offen offset:1024 nt
  s_waitcnt vmcnt(10)
  buffer_load_dwordx4 v[120:123], v2, s[36:39], s53 offen offset:2048 nt
  buffer_load_dwordx4 v[124:127], v2, s[36:39], s53 offen offset:3072 nt
  v_mfma_f32_16x16x16_bf16 v[8:11], v[64:65], v[44:45], v[8:11]
  v_mfma_f32_16x16x16_bf16 v[12:15], v[66:67], v[44:45], v[12:15]
  v_mfma_f32_16x16x16_bf16 v[8:11], v[68:69], v[46:47], v[8:11]
  v_mfma_f32_16x16x16_bf16 v[12:15], v[70:71], v[46:47], v[12:15]
  v_mfma_f32_16x16x16_bf16 v[8:11], v[72:73], v[48:49], v[8:11]
  v_mfma_f32_16x16x16_bf16 v[12:15], v[74:75], v[48:49], v[12:15]
  v_mfma_f32_16x16x16_bf16 v[8:11], v[76:77], v[50:51], v[8:11]
  v_mfma_f32_16x16x16_bf16 v[12:15], v[78:79], v[50:51], v[12:15]
  v_sub_f32 v19, v62, v16
  v_mul_f32 v19, s57, v19
  v_exp_f32 v19, v19
  s_nop 0
  v_add_f32 v18, v18, v19
  v_cvt_pk_bf16_f32 v19, v19, v19
  s_nop 1
  v_and_b32_dpp v44, v19, v22 quad_perm:[0,0,0,0] row_mask:0xf bank_mask:0xf
  v_and_b32_dpp v45, v19, v23 quad_perm:[0,0,0,0] row_mask:0xf bank_mask:0xf
  v_and_b32_dpp v46, v19, v22 quad_perm:[1,1,1,1] row_mask:0xf bank_mask:0xf
  v_and_b32_dpp v47, v19, v23 quad_perm:[1,1,1,1] row_mask:0xf bank_mask:0xf
  v_and_b32_dpp v48, v19, v22 quad_perm:[2,2,2,2] row_mask:0xf bank_mask:0xf
  v_and_b32_dpp v49, v19, v23 quad_perm:[2,2,2,2] row_mask:0xf bank_mask:0xf
  v_and_b32_dpp v50, v19, v22 quad_perm:[3,3,3,3] row_mask:0xf bank_mask:0xf
  v_and_b32_dpp v51, v19, v23 quad_perm:[3,3,3,3] row_mask:0xf bank_mask:0xf
  s_waitcnt vmcnt(10)
  buffer_load_dwordx4 v[64:67], v1, s[32:35], s62 offen offset:0 nt
  buffer_load_dwordx4 v[68:71], v1, s[32:35], s62 offen offset:1024 nt
  s_waitcnt vmcnt(10)
  buffer_load_dwordx4 v[72:75], v1, s[32:35], s62 offen offset:2048 nt
  buffer_load_dwordx4 v[76:79], v1, s[32:35], s62 offen offset:3072 nt
  v_mfma_f32_16x16x16_bf16 v[8:11], v[80:81], v[44:45], v[8:11]
  v_mfma_f32_16x16x16_bf16 v[12:15], v[82:83], v[44:45], v[12:15]
  v_mfma_f32_16x16x16_bf16 v[8:11], v[84:85], v[46:47], v[8:11]
  v_mfma_f32_16x16x16_bf16 v[12:15], v[86:87], v[46:47], v[12:15]
  v_mfma_f32_16x16x16_bf16 v[8:11], v[88:89], v[48:49], v[8:11]
  v_mfma_f32_16x16x16_bf16 v[12:15], v[90:91], v[48:49], v[12:15]
  v_mfma_f32_16x16x16_bf16 v[8:11], v[92:93], v[50:51], v[8:11]
  v_mfma_f32_16x16x16_bf16 v[12:15], v[94:95], v[50:51], v[12:15]
  s_cmp_ge_u32 s53, 0x8000000
  s_mov_b32 s53, s62
  s_cbranch_scc1 L_sdone
  s_branch L_tail1
L_fin1:
  buffer_load_dwordx4 v[120:123], v2, s[36:39], s53 offen offset:2048 nt
  buffer_load_dwordx4 v[124:127], v2, s[36:39], s53 offen offset:3072 nt
  s_waitcnt lgkmcnt(0)
  v_sub_f32 v19, v62, v16
  v_mul_f32 v19, s57, v19
  v_exp_f32 v19, v19
  s_nop 0
  v_add_f32 v18, v18, v19
  v_cvt_pk_bf16_f32 v19, v19, v19
  s_nop 1
  v_and_b32_dpp v44, v19, v22 quad_perm:[0,0,0,0] row_mask:0xf bank_mask:0xf
  v_and_b32_dpp v45, v19, v23 quad_perm:[0,0,0,0] row_mask:0xf bank_mask:0xf
  v_and_b32_dpp v46, v19, v22 quad_perm:[1,1,1,1] row_mask:0xf bank_mask:0xf
  v_and_b32_dpp v47, v19, v23 quad_perm:[1,1,1,1] row_mask:0xf bank_mask:0xf
  v_and_b32_dpp v48, v19, v22 quad_perm:[2,2,2,2] row_mask:0xf bank_mask:0xf
  v_and_b32_dpp v49, v19, v23 quad_perm:[2,2,2,2] row_mask:0xf bank_mask:0xf
  v_and_b32_dpp v50, v19, v22 quad_perm:[3,3,3,3] row_mask:0xf bank_mask:0xf
  v_and_b32_dpp v51, v19, v23 quad_perm:[3,3,3,3] row_mask:0xf bank_mask:0xf
  v_add_u32 v3, 256, v3
  ds_read_b32 v62, v3
  s_mov_b32 s60, 16777216
L_bq37:
  ds_read_b64 v[20:21], v52
  s_waitcnt lgkmcnt(0)
  v_readfirstlane_b32 s66, v20
  v_readfirstlane_b32 s55, v21
  s_sub_u32 s60, s60, 1
  s_cbranch_scc1 L_bqd38
  s_cmp_eq_u32 s55, 0
  s_cbranch_scc1 L_bq37
L_bqd38:
  s_and_b32 s55, s55, 0xffff
  s_add_u32 s66, s66, s3
  s_lshr_b32 s58, s66, 2
  s_and_b32 s59, s58, 63
  v_readlane_b32 s60, v54, s59
  v_readlane_b32 s61, v55, s59
  s_cmp_lt_u32 s58, 64
  s_cselect_b32 s60, s60, s61
  s_and_b32 s58, s66, 3
  s_lshl_b32 s58, s58, 12
  s_add_u32 s60, s60, s58
  s_cmp_lt_u32 s66, s55
  s_cselect_b32 s53, s60, 0x8000000
  s_add_u32 s66, s66, 4
  buffer_load_dwordx4 v[64:67], v1, s[32:35], s53 offen offset:0 nt
  buffer_load_dwordx4 v[68:71], v1, s[32:35], s53 offen offset:1024 nt
  buffer_load_dwordx4 v[72:75], v1, s[32:35], s53 offen offset:2048 nt
  buffer_load_dwordx4 v[76:79], v1, s[32:35], s53 offen offset:3072 nt
  s_cmp_lt_u32 s53, 0x8000000
  s_cbranch_scc1 L_ll39
  v_mov_b32 v53, 0x10000
  ds_write_b32 v61, v53
L_ll39:
  s_lshr_b32 s58, s66, 2
  s_and_b32 s59, s58, 63
  v_readlane_b32 s60, v54, s59
  v_readlane_b32 s61, v55, s59
  s_cmp_lt_u32 s58, 64
  s_cselect_b32 s60, s60, s61
  s_and_b32 s58, s66, 3
  s_lshl_b32 s58, s58, 12
  s_add_u32 s60, s60, s58
  s_cmp_lt_u32 s66, s55
  s_cselect_b32 s62, s60, 0x8000000
  s_add_u32 s66, s66, 4
  s_waitcnt vmcnt(10)
  buffer_load_dwordx4 v[80:83], v2, s[36:39], s53 offen offset:0 nt
  buffer_load_dwordx4 v[84:87], v2, s[36:39], s53 offen offset:1024 nt
  s_waitcnt vmcnt(10)
  buffer_load_dwordx4 v[88:91], v2, s[36:39], s53 offen offset:2048 nt
  buffer_load_dwordx4 v[92:95], v2, s[36:39], s53 offen offset:3072 nt
  v_mfma_f32_16x16x16_bf16 v[8:11], v[96:97], v[44:45], v[8:11]
  v_mfma_f32_16x16x16_bf16 v[12:15], v[98:99], v[44:45], v[12:15]
  v_mfma_f32_16x16x16_bf16 v[8:11], v[100:101], v[46:47], v[8:11]
  v_mfma_f32_16x16x16_bf16 v[12:15], v[102:103], v[46:47], v[12:15]
  v_mfma_f32_16x16x16_bf16 v[8:11], v[104:105], v[48:49], v[8:11]
  v_mfma_f32_16x16x16_bf16 v[12:15], v[106:107], v[48:49], v[12:15]
  v_mfma_f32_16x16x16_bf16 v[8:11], v[108:109], v[50:51], v[8:11]
  v_mfma_f32_16x16x16_bf16 v[12:15], v[110:111], v[50:51], v[12:15]
  v_sub_f32 v19, v62, v16
  v_mul_f32 v19, s57, v19
  v_exp_f32 v19, v19
  s_nop 0
  v_add_f32 v18, v18, v19
  v_cvt_pk_bf16_f32 v19, v19, v19
  s_nop 1
  v_and_b32_dpp v44, v19, v22 quad_perm:[0,0,0,0] row_mask:0xf bank_mask:0xf
  v_and_b32_dpp v45, v19, v23 quad_perm:[0,0,0,0] row_mask:0xf bank_mask:0xf
  v_and_b32_dpp v46, v19, v22 quad_perm:[1,1,1,1] row_mask:0xf bank_mask:0xf
  v_and_b32_dpp v47, v19, v23 quad_perm:[1,1,1,1] row_mask:0xf bank_mask:0xf
  v_and_b32_dpp v48, v19, v22 quad_perm:[2,2,2,2] row_mask:0xf bank_mask:0xf
  v_and_b32_dpp v49, v19, v23 quad_perm:[2,2,2,2] row_mask:0xf bank_mask:0xf
  v_and_b32_dpp v50, v19, v22 quad_perm:[3,3,3,3] row_mask:0xf bank_mask:0xf
  v_and_b32_dpp v51, v19, v23 quad_perm:[3,3,3,3] row_mask:0xf bank_mask:0xf
  s_waitcnt vmcnt(10)
  buffer_load_dwordx4 v[96:99], v1, s[32:35], s62 offen offset:0 nt
  buffer_load_dwordx4 v[100:103], v1, s[32:35], s62 offen offset:1024 nt
  s_waitcnt vmcnt(10)
  buffer_load_dwordx4 v[104:107], v1, s[32:35], s62 offen offset:2048 nt
  buffer_load_dwordx4 v[108:111], v1, s[32:35], s62 offen offset:3072 nt
  v_mfma_f32_16x16x16_bf16 v[8:11], v[112:113], v[44:45], v[8:11]
  v_mfma_f32_16x16x16_bf16 v[12:15], v[114:115], v[44:45], v[12:15]
  v_mfma_f32_16x16x16_bf16 v[8:11], v[116:117], v[46:47], v[8:11]
  v_mfma_f32_16x16x16_bf16 v[12:15], v[118:119], v[46:47], v[12:15]
  v_mfma_f32_16x16x16_bf16 v[8:11], v[120:121], v[48:49], v[8:11]
  v_mfma_f32_16x16x16_bf16 v[12:15], v[122:123], v[48:49], v[12:15]
  v_mfma_f32_16x16x16_bf16 v[8:11], v[124:125], v[50:51], v[8:11]
  v_mfma_f32_16x16x16_bf16 v[12:15], v[126:127], v[50:51], v[12:15]
  s_cmp_ge_u32 s53, 0x8000000
  s_mov_b32 s53, s62
  s_cbranch_scc1 L_sdone
  s_branch L_tail0
L_tail0:
  s_cmp_lt_u32 s53, 0x8000000
  s_cbranch_scc1 L_ll40
  v_mov_b32 v53, 0x10000
  ds_write_b32 v61, v53
L_ll40:
  s_lshr_b32 s58, s66, 2
  s_and_b32 s59, s58, 63
  v_readlane_b32 s60, v54, s59
  v_readlane_b32 s61, v55, s59
  s_cmp_lt_u32 s58, 64
  s_cselect_b32 s60, s60, s61
  s_and_b32 s58, s66, 3
  s_lshl_b32 s58, s58, 12
  s_add_u32 s60, s60, s58
  s_cmp_lt_u32 s66, s55
  s_cselect_b32 s62, s60, 0x8000000
  s_add_u32 s66, s66, 4
  s_waitcnt vmcnt(10)
  buffer_load_dwordx4 v[112:115], v2, s[36:39], s53 offen offset:0 nt
  buffer_load_dwordx4 v[116:119], v2, s[36:39], s53 offen offset:1024 nt
  s_waitcnt vmcnt(10)
  buffer_load_dwordx4 v[120:123], v2, s[36:39], s53 offen offset:2048 nt
  buffer_load_dwordx4 v[124:127], v2, s[36:39], s53 offen offset:3072 nt
  v_mfma_f32_16x16x32_bf16 v[28:31], v[64:67], v[4:7], 0
  v_mfma_f32_16x16x32_bf16 v[32:35], v[68:71], v[4:7], 0
  v_mfma_f32_16x16x32_bf16 v[36:39], v[72:75], v[4:7], 0
  v_mfma_f32_16x16x32_bf16 v[40:43], v[76:79], v[4:7], 0
  s_nop 4
  v_mul_f32_dpp v19, v28, v24 quad_perm:[0,0,0,0] row_mask:0xf bank_mask:0xf
  v_fmac_f32_dpp v19, v29, v24 quad_perm:[1,1,1,1] row_mask:0xf bank_mask:0xf
  v_fmac_f32_dpp v19, v30, v24 quad_perm:[2,2,2,2] row_mask:0xf bank_mask:0xf
  v_fmac_f32_dpp v19, v31, v24 quad_perm:[3,3,3,3] row_mask:0xf bank_mask:0xf
  v_fmac_f32_dpp v19, v32, v25 quad_perm:[0,0,0,0] row_mask:0xf bank_mask:0xf
  v_fmac_f32_dpp v19, v33, v25 quad_perm:[1,1,1,1] row_mask:0xf bank_mask:0xf
  v_fmac_f32_dpp v19, v34, v25 quad_perm:[2,2,2,2] row_mask:0xf bank_mask:0xf
  v_fmac_f32_dpp v19, v35, v25 quad_perm:[3,3,3,3] row_mask:0xf bank_mask:0xf
  v_fmac_f32_dpp v19, v36, v26 quad_perm:[0,0,0,0] row_mask:0xf bank_mask:0xf
  v_fmac_f32_dpp v19, v37, v26 quad_perm:[1,1,1,1] row_mask:0xf bank_mask:0xf
  v_fmac_f32_dpp v19, v38, v26 quad_perm:[2,2,2,2] row_mask:0xf bank_mask:0xf
  v_fmac_f32_dpp v19, v39, v26 quad_perm:[3,3,3,3] row_mask:0xf bank_mask:0xf
  v_fmac_f32_dpp v19, v40, v27 quad_perm:[0,0,0,0] row_mask:0xf bank_mask:0xf
  v_fmac_f32_dpp v19, v41, v27 quad_perm:[1,1,1,1] row_mask:0xf bank_mask:0xf
  v_fmac_f32_dpp v19, v42, v27 quad_perm:[2,2,2,2] row_mask:0xf bank_mask:0xf
  v_fmac_f32_dpp v19, v43, v27 quad_perm:[3,3,3,3] row_mask:0xf bank_mask:0xf
  v_cvt_pk_bf16_f32 v19, v19, v19
  v_and_b32 v19, 0xffff0000, v19
  v_mul_f32 v19, s56, v19
  v_cvt_pk_bf16_f32 v19, v19, v19
  v_and_b32 v19, 0xffff0000, v19
  v_cmp_gt_f32 vcc, v19, v16
  s_cbranch_vccz L_nomax41
  v_max_f32 v20, v19, v16
  v_mov_b32 v17, v16
  s_nop 0
  v_max_f32_dpp v20, v20, v20 quad_perm:[1,0,3,2] row_mask:0xf bank_mask:0xf
  s_nop 1
  v_max_f32_dpp v20, v20, v20 quad_perm:[2,3,0,1] row_mask:0xf bank_mask:0xf
  v_mov_b32 v21, v20
  s_nop 1
  v_permlane16_swap_b32 v20, v21
  v_max_f32 v20, v20, v21
  v_mov_b32 v21, v20
  s_nop 1
  v_permlane32_swap_b32 v20, v21
  v_max_f32 v16, v20, v21
  v_sub_f32 v21, v17, v16
  v_mul_f32 v21, s57, v21
  v_exp_f32 v21, v21
  s_nop 0
  v_mul_f32 v8, v21, v8
  v_mul_f32 v9, v21, v9
  v_mul_f32 v10, v21, v10
  v_mul_f32 v11, v21, v11
  v_mul_f32 v12, v21, v12
  v_mul_f32 v13, v21, v13
  v_mul_f32 v14, v21, v14
  v_mul_f32 v15, v21, v15
  v_mul_f32 v18, v21, v18
L_nomax41:
  v_sub_f32 v19, v19, v16
  v_mul_f32 v19, s57, v19
  v_exp_f32 v19, v19
  s_nop 0
  v_add_f32 v18, v18, v19
  v_cvt_pk_bf16_f32 v19, v19, v19
  s_nop 1
  v_and_b32_dpp v44, v19, v22 quad_perm:[0,0,0,0] row_mask:0xf bank_mask:0xf
  v_and_b32_dpp v45, v19, v23 quad_perm:[0,0,0,0] row_mask:0xf bank_mask:0xf
  v_and_b32_dpp v46, v19, v22 quad_perm:[1,1,1,1] row_mask:0xf bank_mask:0xf
  v_and_b32_dpp v47, v19, v23 quad_perm:[1,1,1,1] row_mask:0xf bank_mask:0xf
  v_and_b32_dpp v48, v19, v22 quad_perm:[2,2,2,2] row_mask:0xf bank_mask:0xf
  v_and_b32_dpp v49, v19, v23 quad_perm:[2,2,2,2] row_mask:0xf bank_mask:0xf
  v_and_b32_dpp v50, v19, v22 quad_perm:[3,3,3,3] row_mask:0xf bank_mask:0xf
  v_and_b32_dpp v51, v19, v23 quad_perm:[3,3,3,3] row_mask:0xf bank_mask:0xf
  s_waitcnt vmcnt(10)
  buffer_load_dwordx4 v[64:67], v1, s[32:35], s62 offen offset:0 nt
  buffer_load_dwordx4 v[68:71], v1, s[32:35], s62 offen offset:1024 nt
  s_waitcnt vmcnt(10)
  buffer_load_dwordx4 v[72:75], v1, s[32:35], s62 offen offset:2048 nt
  buffer_load_dwordx4 v[76:79], v1, s[32:35], s62 offen offset:3072 nt
  v_mfma_f32_16x16x16_bf16 v[8:11], v[80:81], v[44:45], v[8:11]
  v_mfma_f32_16x16x16_bf16 v[12:15], v[82:83], v[44:45], v[12:15]
  v_mfma_f32_16x16x16_bf16 v[8:11], v[84:85], v[46:47], v[8:11]
  v_mfma_f32_16x16x16_bf16 v[12:15], v[86:87], v[46:47], v[12:15]
  v_mfma_f32_16x16x16_bf16 v[8:11], v[88:89], v[48:49], v[8:11]
  v_mfma_f32_16x16x16_bf16 v[12:15], v[90:91], v[48:49], v[12:15]
  v_mfma_f32_16x16x16_bf16 v[8:11], v[92:93], v[50:51], v[8:11]
  v_mfma_f32_16x16x16_bf16 v[12:15], v[94:95], v[50:51], v[12:15]
  s_cmp_ge_u32 s53, 0x8000000
  s_mov_b32 s53, s62
  s_cbranch_scc1 L_sdone
L_tail1:
  s_cmp_lt_u32 s53, 0x8000000
  s_cbranch_scc1 L_ll42
  v_mov_b32 v53, 0x10000
  ds_write_b32 v61, v53
L_ll42:
  s_lshr_b32 s58, s66, 2
  s_and_b32 s59, s58, 63
  v_readlane_b32 s60, v54, s59
  v_readlane_b32 s61, v55, s59
  s_cmp_lt_u32 s58, 64
  s_cselect_b32 s60, s60, s61
  s_and_b32 s58, s66, 3
  s_lshl_b32 s58, s58, 12
  s_add_u32 s60, s60, s58
  s_cmp_lt_u32 s66, s55
  s_cselect_b32 s62, s60, 0x8000000
  s_add_u32 s66, s66, 4
  s_waitcnt vmcnt(10)
  buffer_load_dwordx4 v[80:83], v2, s[36:39], s53 offen offset:0 nt
  buffer_load_dwordx4 v[84:87], v2, s[36:39], s53 offen offset:1024 nt
  s_waitcnt vmcnt(10)
  buffer_load_dwordx4 v[88:91], v2, s[36:39], s53 offen offset:2048 nt
  buffer_load_dwordx4 v[92:95], v2, s[36:39], s53 offen offset:3072 nt
  v_mfma_f32_16x16x32_bf16 v[28:31], v[96:99], v[4:7], 0
  v_mfma_f32_16x16x32_bf16 v[32:35], v[100:103], v[4:7], 0
  v_mfma_f32_16x16x32_bf16 v[36:39], v[104:107], v[4:7], 0
  v_mfma_f32_16x16x32_bf16 v[40:43], v[108:111], v[4:7], 0
  s_nop 4
  v_mul_f32_dpp v19, v28, v24 quad_perm:[0,0,0,0] row_mask:0xf bank_mask:0xf
  v_fmac_f32_dpp v19, v29, v24 quad_perm:[1,1,1,1] row_mask:0xf bank_mask:0xf
  v_fmac_f32_dpp v19, v30, v24 quad_perm:[2,2,2,2] row_mask:0xf bank_mask:0xf
  v_fmac_f32_dpp v19, v31, v24 quad_perm:[3,3,3,3] row_mask:0xf bank_mask:0xf
  v_fmac_f32_dpp v19, v32, v25 quad_perm:[0,0,0,0] row_mask:0xf bank_mask:0xf
  v_fmac_f32_dpp v19, v33, v25 quad_perm:[1,1,1,1] row_mask:0xf bank_mask:0xf
  v_fmac_f32_dpp v19, v34, v25 quad_perm:[2,2,2,2] row_mask:0xf bank_mask:0xf
  v_fmac_f32_dpp v19, v35, v25 quad_perm:[3,3,3,3] row_mask:0xf bank_mask:0xf
  v_fmac_f32_dpp v19, v36, v26 quad_perm:[0,0,0,0] row_mask:0xf bank_mask:0xf
  v_fmac_f32_dpp v19, v37, v26 quad_perm:[1,1,1,1] row_mask:0xf bank_mask:0xf
  v_fmac_f32_dpp v19, v38, v26 quad_perm:[2,2,2,2] row_mask:0xf bank_mask:0xf
  v_fmac_f32_dpp v19, v39, v26 quad_perm:[3,3,3,3] row_mask:0xf bank_mask:0xf
  v_fmac_f32_dpp v19, v40, v27 quad_perm:[0,0,0,0] row_mask:0xf bank_mask:0xf
  v_fmac_f32_dpp v19, v41, v27 quad_perm:[1,1,1,1] row_mask:0xf bank_mask:0xf
  v_fmac_f32_dpp v19, v42, v27 quad_perm:[2,2,2,2] row_mask:0xf bank_mask:0xf
  v_fmac_f32_dpp v19, v43, v27 quad_perm:[3,3,3,3] row_mask:0xf bank_mask:0xf
  v_cvt_pk_bf16_f32 v19, v19, v19
  v_and_b32 v19, 0xffff0000, v19
  v_mul_f32 v19, s56, v19
  v_cvt_pk_bf16_f32 v19, v19, v19
  v_and_b32 v19, 0xffff0000, v19
  v_cmp_gt_f32 vcc, v19, v16
  s_cbranch_vccz L_nomax43
  v_max_f32 v20, v19, v16
  v_mov_b32 v17, v16
  s_nop 0
  v_max_f32_dpp v20, v20, v20 quad_perm:[1,0,3,2] row_mask:0xf bank_mask:0xf
  s_nop 1
  v_max_f32_dpp v20, v20, v20 quad_perm:[2,3,0,1] row_mask:0xf bank_mask:0xf
  v_mov_b32 v21, v20
  s_nop 1
  v_permlane16_swap_b32 v20, v21
  v_max_f32 v20, v20, v21
  v_mov_b32 v21, v20
  s_nop 1
  v_permlane32_swap_b32 v20, v21
  v_max_f32 v16, v20, v21
  v_sub_f32 v21, v17, v16
  v_mul_f32 v21, s57, v21
  v_exp_f32 v21, v21
  s_nop 0
  v_mul_f32 v8, v21, v8
  v_mul_f32 v9, v21, v9
  v_mul_f32 v10, v21, v10
  v_mul_f32 v11, v21, v11
  v_mul_f32 v12, v21, v12
  v_mul_f32 v13, v21, v13
  v_mul_f32 v14, v21, v14
  v_mul_f32 v15, v21, v15
  v_mul_f32 v18, v21, v18
L_nomax43:
  v_sub_f32 v19, v19, v16
  v_mul_f32 v19, s57, v19
  v_exp_f32 v19, v19
  s_nop 0
  v_add_f32 v18, v18, v19
  v_cvt_pk_bf16_f32 v19, v19, v19
  s_nop 1
  v_and_b32_dpp v44, v19, v22 quad_perm:[0,0,0,0] row_mask:0xf bank_mask:0xf
  v_and_b32_dpp v45, v19, v23 quad_perm:[0,0,0,0] row_mask:0xf bank_mask:0xf
  v_and_b32_dpp v46, v19, v22 quad_perm:[1,1,1,1] row_mask:0xf bank_mask:0xf
  v_and_b32_dpp v47, v19, v23 quad_perm:[1,1,1,1] row_mask:0xf bank_mask:0xf
  v_and_b32_dpp v48, v19, v22 quad_perm:[2,2,2,2] row_mask:0xf bank_mask:0xf
  v_and_b32_dpp v49, v19, v23 quad_perm:[2,2,2,2] row_mask:0xf bank_mask:0xf
  v_and_b32_dpp v50, v19, v22 quad_perm:[3,3,3,3] row_mask:0xf bank_mask:0xf
  v_and_b32_dpp v51, v19, v23 quad_perm:[3,3,3,3] row_mask:0xf bank_mask:0xf
  s_waitcnt vmcnt(10)
  buffer_load_dwordx4 v[96:99], v1, s[32:35], s62 offen offset:0 nt
  buffer_load_dwordx4 v[100:103], v1, s[32:35], s62 offen offset:1024 nt
  s_waitcnt vmcnt(10)
  buffer_load_dwordx4 v[104:107], v1, s[32:35], s62 offen offset:2048 nt
  buffer_load_dwordx4 v[108:111], v1, s[32:35], s62 offen offset:3072 nt
  v_mfma_f32_16x16x16_bf16 v[8:11], v[112:113], v[44:45], v[8:11]
  v_mfma_f32_16x16x16_bf16 v[12:15], v[114:115], v[44:45], v[12:15]
  v_mfma_f32_16x16x16_bf16 v[8:11], v[116:117], v[46:47], v[8:11]
  v_mfma_f32_16x16x16_bf16 v[12:15], v[118:119], v[46:47], v[12:15]
  v_mfma_f32_16x16x16_bf16 v[8:11], v[120:121], v[48:49], v[8:11]
  v_mfma_f32_16x16x16_bf16 v[12:15], v[122:123], v[48:49], v[12:15]
  v_mfma_f32_16x16x16_bf16 v[8:11], v[124:125], v[50:51], v[8:11]
  v_mfma_f32_16x16x16_bf16 v[12:15], v[126:127], v[50:51], v[12:15]
  s_cmp_ge_u32 s53, 0x8000000
  s_mov_b32 s53, s62
  s_cbranch_scc0 L_tail0
L_sdone:
  v_mov_b32 v17, v18
  ds_write_b64 v57, v[16:17] offset:2048
  s_nop 1
  ds_write_b128 v56, v[8:11]
  ds_write_b128 v56, v[12:15] offset:64
  s_waitcnt lgkmcnt(0)
  s_barrier
  s_cmp_eq_u32 s3, 3
  s_cbranch_scc1 L_e0x
  ds_read_b64 v[28:29], v59 offset:0
  ds_read_b64 v[30:31], v59 offset:2560
  ds_read_b64 v[32:33], v59 offset:5120
  ds_read_b64 v[34:35], v59 offset:7680
  s_cmp_eq_u32 s3, 2
  s_cbranch_scc1 L_e0ml
  ds_read_b128 v[36:39], v58 offset:0
  ds_read_b128 v[40:43], v58 offset:2560
  ds_read_b128 v[44:47], v58 offset:5120
  ds_read_b128 v[48:51], v58 offset:7680
  s_waitcnt lgkmcnt(4)
  v_max3_f32 v4, v28, v30, v32
  v_max_f32 v4, v4, v34
  v_sub_f32 v5, v28, v4
  v_sub_f32 v6, v30, v4
  v_sub_f32 v7, v32, v4
  v_sub_f32 v8, v34, v4
  v_mul_f32 v5, s57, v5
  v_mul_f32 v6, s57, v6
  v_mul_f32 v7, s57, v7
  v_mul_f32 v8, s57, v8
  v_exp_f32 v5, v5
  v_exp_f32 v6, v6
  v_exp_f32 v7, v7
  v_exp_f32 v8, v8
  s_waitcnt lgkmcnt(3)
  v_mul_f32 v12, v5, v36
  v_mul_f32 v13, v5, v37
  v_mul_f32 v14, v5, v38
  v_mul_f32 v15, v5, v39
  s_waitcnt lgkmcnt(2)
  v_fmac_f32 v12, v6, v40
  v_fmac_f32 v13, v6, v41
  v_fmac_f32 v14, v6, v42
  v_fmac_f32 v15, v6, v43
  s_waitcnt lgkmcnt(1)
  v_fmac_f32 v12, v7, v44
  v_fmac_f32 v13, v7, v45
  v_fmac_f32 v14, v7, v46
  v_fmac_f32 v15, v7, v47
  s_waitcnt lgkmcnt(0)
  v_fmac_f32 v12, v8, v48
  v_fmac_f32 v13, v8, v49
  v_fmac_f32 v14, v8, v50
  v_fmac_f32 v15, v8, v51
  v_min_u32 v12, -2, v12
  v_min_u32 v13, -2, v13
  v_min_u32 v14, -2, v14
  v_min_u32 v15, -2, v15
  buffer_store_dwordx4 v[12:15], v2, s[40:43], s67 offen sc1
L_e0x:
  s_barrier
  s_endpgm
L_e0ml:
  s_waitcnt lgkmcnt(0)
  v_max3_f32 v4, v28, v30, v32
  v_max_f32 v4, v4, v34
  v_sub_f32 v6, v28, v4
  v_sub_f32 v7, v30, v4
  v_sub_f32 v8, v32, v4
  v_sub_f32 v9, v34, v4
  v_mul_f32 v6, s57, v6
  v_mul_f32 v7, s57, v7
  v_mul_f32 v8, s57, v8
  v_mul_f32 v9, s57, v9
  v_exp_f32 v6, v6
  v_exp_f32 v7, v7
  v_exp_f32 v8, v8
  v_exp_f32 v9, v9
  v_mul_f32 v5, v6, v29
  v_fmac_f32 v5, v7, v31
  v_fmac_f32 v5, v8, v33
  v_fmac_f32 v5, v9, v35
  s_nop 1
  v_add_f32_dpp v5, v5, v5 quad_perm:[1,0,3,2] row_mask:0xf bank_mask:0xf
  s_nop 1
  v_add_f32_dpp v5, v5, v5 quad_perm:[2,3,0,1] row_mask:0xf bank_mask:0xf
  v_mov_b32 v6, v5
  s_nop 1
  v_permlane16_swap_b32 v5, v6
  v_add_f32 v5, v5, v6
  v_mov_b32 v6, v5
  s_nop 1
  v_permlane32_swap_b32 v5, v6
  v_add_f32 v5, v5, v6
  v_min_u32 v4, -2, v4
  v_min_u32 v5, -2, v5
  s_mov_b64 exec, 0xffff
  buffer_store_dwordx2 v[4:5], v58, s[40:43], s67 offen sc1
  s_mov_b64 exec, -1
  s_barrier
  s_endpgm
L_e1:
  v_lshlrev_b32 v3, 14, v8
  v_lshl_add_u32 v3, v9, 4, v3
  v_and_b32 v4, 7, v0
  v_lshl_add_u32 v4, v8, 3, v4
  v_lshlrev_b32 v4, 7, v4
  s_lshl_b32 s68, s53, 16
  s_lshl_b32 s58, s64, 8
  s_add_u32 s68, s68, s58
  s_add_u32 s68, s68, 262144
  s_add_u32 s70, s68, 4096
  s_add_u32 s71, s68, 8192
  s_add_u32 s72, s68, 12288
  s_lshr_b32 s58, s64, 1
  s_lshl_b32 s58, s58, 5
  s_lshl_b32 s69, s53, 12
  s_add_u32 s69, s69, s58
  s_add_u32 s69, s69, 786432
  s_lshl_b32 s58, s52, 8
  s_add_u32 s58, s58, 81920
  v_add_u32 v14, s58, v0
  v_lshlrev_b32 v15, 4, v9
  v_lshl_add_u32 v13, v8, 15, v15
  v_add_u32 v15, 81920, v15
  s_lshl_b32 s73, s53, 1
  s_lshr_b32 s58, s54, 3
  s_add_u32 s73, s73, s58
  s_lshl_b32 s73, s73, 11
  s_lshl_b32 s58, s66, 8
  s_add_u32 s73, s73, s58
  s_add_u32 s73, s73, 933888
  s_lshl_b32 s58, s52, 17
  s_add_u32 s73, s73, s58
  v_add_u32 v5, s56, v5
  s_waitcnt vmcnt(0)
  v_xor_b32 v10, 0, v5
  v_xor_b32 v10, 32, v5
  v_xor_b32 v10, 64, v5
  v_xor_b32 v10, 96, v5
  s_waitcnt lgkmcnt(0)
  s_branch L_bal
L_e1b:
  s_mov_b32 s44, s12
  s_mov_b32 s45, s13
  s_mov_b32 s46, 0x400000
  s_mov_b32 s47, 0x20000
  v_lshrrev_b32 v31, 3, v0
  s_mov_b32 s59, 1024
  v_mul_lo_u32 v31, v31, s59
  v_xor_b32 v30, 64, v62
  v_add_u32 v30, v30, v31
  v_add_u32 v31, v31, v62
  s_add_u32 m0, s56, 0
  s_add_u32 s59, s67, 0
  buffer_load_dwordx4 v31, s[44:47], s59 offen lds
  s_add_u32 m0, s56, 1024
  s_add_u32 s59, s67, 8192
  buffer_load_dwordx4 v30, s[44:47], s59 offen lds
  s_add_u32 m0, s56, 2048
  s_add_u32 s59, s67, 16384
  buffer_load_dwordx4 v31, s[44:47], s59 offen lds
  s_add_u32 m0, s56, 3072
  s_add_u32 s59, s67, 24576
  buffer_load_dwordx4 v30, s[44:47], s59 offen lds
  s_add_u32 m0, s56, 4096
  s_add_u32 s59, s67, 32768
  buffer_load_dwordx4 v31, s[44:47], s59 offen lds
  s_add_u32 m0, s56, 5120
  s_add_u32 s59, s67, 40960
  buffer_load_dwordx4 v30, s[44:47], s59 offen lds
  s_add_u32 m0, s56, 6144
  s_add_u32 s59, s67, 49152
  buffer_load_dwordx4 v31, s[44:47], s59 offen lds
  s_add_u32 m0, s56, 7168
  s_add_u32 s59, s67, 57344
  buffer_load_dwordx4 v30, s[44:47], s59 offen lds
  s_barrier
  s_barrier
  s_waitcnt vmcnt(0)
  v_xor_b32 v10, 0, v5
  ds_read_b64_tr_b16 v[64:65], v10 offset:0
  ds_read_b64_tr_b16 v[66:67], v10 offset:512
  ds_read_b64_tr_b16 v[68:69], v10 offset:4096
  ds_read_b64_tr_b16 v[70:71], v10 offset:4608
  v_xor_b32 v10, 32, v5
  ds_read_b64_tr_b16 v[72:73], v10 offset:0
  ds_read_b64_tr_b16 v[74:75], v10 offset:512
  ds_read_b64_tr_b16 v[76:77], v10 offset:4096
  ds_read_b64_tr_b16 v[78:79], v10 offset:4608
  v_xor_b32 v10, 64, v5
  ds_read_b64_tr_b16 v[80:81], v10 offset:0
  ds_read_b64_tr_b16 v[82:83], v10 offset:512
  ds_read_b64_tr_b16 v[84:85], v10 offset:4096
  ds_read_b64_tr_b16 v[86:87], v10 offset:4608
  v_xor_b32 v10, 96, v5
  ds_read_b64_tr_b16 v[88:89], v10 offset:0
  ds_read_b64_tr_b16 v[90:91], v10 offset:512
  ds_read_b64_tr_b16 v[92:93], v10 offset:4096
  ds_read_b64_tr_b16 v[94:95], v10 offset:4608
  s_mov_b32 s60, 524288
L_pe144:
  buffer_load_dwordx2 v[96:97], v4, s[40:43], s69 offen sc1
  buffer_load_dwordx4 v[128:131], v3, s[40:43], s68 offen offset:0 sc1
  buffer_load_dwordx4 v[132:135], v3, s[40:43], s68 offen offset:2048 sc1
  buffer_load_dwordx4 v[136:139], v3, s[40:43], s70 offen offset:0 sc1
  buffer_load_dwordx4 v[140:143], v3, s[40:43], s70 offen offset:2048 sc1
  buffer_load_dwordx4 v[144:147], v3, s[40:43], s71 offen offset:0 sc1
  buffer_load_dwordx4 v[148:151], v3, s[40:43], s71 offen offset:2048 sc1
  buffer_load_dwordx4 v[152:155], v3, s[40:43], s72 offen offset:0 sc1
  buffer_load_dwordx4 v[156:159], v3, s[40:43], s72 offen offset:2048 sc1
  s_mov_b64 exec, -1
L_pe1sl46:
  s_waitcnt vmcnt(8)
  v_mov_b32 v25, v96
  v_mov_b32 v26, v97
  s_nop 0
  v_max_f32_dpp v16, v25, v25 row_ror:1 row_mask:0xf bank_mask:0xf
  s_nop 1
  v_max_f32_dpp v16, v16, v16 row_ror:2 row_mask:0xf bank_mask:0xf
  s_nop 1
  v_max_f32_dpp v16, v16, v16 row_ror:4 row_mask:0xf bank_mask:0xf
  v_mov_b32 v17, v16
  s_nop 1
  v_permlane16_swap_b32 v16, v17
  v_max_f32 v16, v16, v17
  v_mov_b32 v17, v16
  s_nop 1
  v_permlane32_swap_b32 v16, v17
  v_max_f32 v16, v16, v17
  v_sub_f32 v24, v25, v16
  v_mul_f32 v24, 0x3fb8aa3b, v24
  v_exp_f32 v24, v24
  s_waitcnt vmcnt(7)
  s_nop 0
  v_mul_f32_dpp v20, v24, v128 row_newbcast:0 row_mask:0xf bank_mask:0xf
  v_mul_f32_dpp v21, v24, v129 row_newbcast:0 row_mask:0xf bank_mask:0xf
  v_mul_f32 v18, v24, v26
  v_mul_f32_dpp v22, v24, v130 row_newbcast:0 row_mask:0xf bank_mask:0xf
  v_mul_f32_dpp v23, v24, v131 row_newbcast:0 row_mask:0xf bank_mask:0xf
  v_add_f32_dpp v18, v18, v18 row_ror:1 row_mask:0xf bank_mask:0xf
  s_waitcnt vmcnt(6)
  v_fmac_f32_dpp v20, v24, v132 row_newbcast:1 row_mask:0xf bank_mask:0xf
  v_fmac_f32_dpp v21, v24, v133 row_newbcast:1 row_mask:0xf bank_mask:0xf
  v_add_f32_dpp v18, v18, v18 row_ror:2 row_mask:0xf bank_mask:0xf
  v_fmac_f32_dpp v22, v24, v134 row_newbcast:1 row_mask:0xf bank_mask:0xf
  v_fmac_f32_dpp v23, v24, v135 row_newbcast:1 row_mask:0xf bank_mask:0xf
  v_add_f32_dpp v18, v18, v18 row_ror:4 row_mask:0xf bank_mask:0xf
  s_waitcnt vmcnt(5)
  v_fmac_f32_dpp v20, v24, v136 row_newbcast:2 row_mask:0xf bank_mask:0xf
  v_fmac_f32_dpp v21, v24, v137 row_newbcast:2 row_mask:0xf bank_mask:0xf
  v_mov_b32 v19, v18
  v_fmac_f32_dpp v22, v24, v138 row_newbcast:2 row_mask:0xf bank_mask:0xf
  v_fmac_f32_dpp v23, v24, v139 row_newbcast:2 row_mask:0xf bank_mask:0xf
  v_mov_b32 v17, v18
  s_waitcnt vmcnt(4)
  v_fmac_f32_dpp v20, v24, v140 row_newbcast:3 row_mask:0xf bank_mask:0xf
  v_fmac_f32_dpp v21, v24, v141 row_newbcast:3 row_mask:0xf bank_mask:0xf
  v_permlane16_swap_b32 v18, v17
  v_fmac_f32_dpp v22, v24, v142 row_newbcast:3 row_mask:0xf bank_mask:0xf
  v_fmac_f32_dpp v23, v24, v143 row_newbcast:3 row_mask:0xf bank_mask:0xf
  v_add_f32 v18, v18, v17
  s_waitcnt vmcnt(3)
  v_fmac_f32_dpp v20, v24, v144 row_newbcast:4 row_mask:0xf bank_mask:0xf
  v_fmac_f32_dpp v21, v24, v145 row_newbcast:4 row_mask:0xf bank_mask:0xf
  v_mov_b32 v17, v18
  v_fmac_f32_dpp v22, v24, v146 row_newbcast:4 row_mask:0xf bank_mask:0xf
  v_fmac_f32_dpp v23, v24, v147 row_newbcast:4 row_mask:0xf bank_mask:0xf
  v_permlane32_swap_b32 v18, v17
  s_waitcnt vmcnt(2)
  v_fmac_f32_dpp v20, v24, v148 row_newbcast:5 row_mask:0xf bank_mask:0xf
  v_fmac_f32_dpp v21, v24, v149 row_newbcast:5 row_mask:0xf bank_mask:0xf
  v_add_f32 v18, v18, v17
  v_fmac_f32_dpp v22, v24, v150 row_newbcast:5 row_mask:0xf bank_mask:0xf
  v_fmac_f32_dpp v23, v24, v151 row_newbcast:5 row_mask:0xf bank_mask:0xf
  v_rcp_f32 v18, v18
  s_waitcnt vmcnt(1)
  v_fmac_f32_dpp v20, v24, v152 row_newbcast:6 row_mask:0xf bank_mask:0xf
  v_fmac_f32_dpp v21, v24, v153 row_newbcast:6 row_mask:0xf bank_mask:0xf
  v_fmac_f32_dpp v22, v24, v154 row_newbcast:6 row_mask:0xf bank_mask:0xf
  v_fmac_f32_dpp v23, v24, v155 row_newbcast:6 row_mask:0xf bank_mask:0xf
  s_waitcnt vmcnt(0)
  v_fmac_f32_dpp v20, v24, v156 row_newbcast:7 row_mask:0xf bank_mask:0xf
  v_fmac_f32_dpp v21, v24, v157 row_newbcast:7 row_mask:0xf bank_mask:0xf
  v_fmac_f32_dpp v22, v24, v158 row_newbcast:7 row_mask:0xf bank_mask:0xf
  v_fmac_f32_dpp v23, v24, v159 row_newbcast:7 row_mask:0xf bank_mask:0xf
  v_add_f32 v19, v19, v20
  v_add_f32 v17, v21, v22
  v_add_f32 v19, v19, v23
  v_cmp_u_f32 vcc, v19, v17
  s_cbranch_vccz L_pe1ok45
  s_sub_u32 s60, s60, 1
  s_and_b32 s58, s60, 63
  s_mov_b64 exec, vcc
  s_cbranch_scc1 L_pe144
  s_mov_b64 exec, -1
  s_waitcnt vmcnt(0)
  v_max_u32 v10, v96, v97
  v_max3_u32 v10, v10, v128, v129
  v_max3_u32 v10, v10, v130, v131
  v_max3_u32 v10, v10, v132, v133
  v_max3_u32 v10, v10, v134, v135
  v_max3_u32 v10, v10, v136, v137
  v_max3_u32 v10, v10, v138, v139
  v_max3_u32 v10, v10, v140, v141
  v_max3_u32 v10, v10, v142, v143
  v_max3_u32 v10, v10, v144, v145
  v_max3_u32 v10, v10, v146, v147
  v_max3_u32 v10, v10, v148, v149
  v_max3_u32 v10, v10, v150, v151
  v_max3_u32 v10, v10, v152, v153
  v_max3_u32 v10, v10, v154, v155
  v_max3_u32 v10, v10, v156, v157
  v_max3_u32 v10, v10, v158, v159
  v_cmp_eq_u32 vcc, -1, v10
  s_cbranch_vccz L_pe1fin47
  s_cmp_eq_u32 s60, 0
  s_cbranch_scc0 L_pe144
L_pe1fin47:
  s_waitcnt vmcnt(8)
  v_mov_b32 v25, v96
  v_mov_b32 v26, v97
  s_nop 0
  v_max_f32_dpp v16, v25, v25 row_ror:1 row_mask:0xf bank_mask:0xf
  s_nop 1
  v_max_f32_dpp v16, v16, v16 row_ror:2 row_mask:0xf bank_mask:0xf
  s_nop 1
  v_max_f32_dpp v16, v16, v16 row_ror:4 row_mask:0xf bank_mask:0xf
  v_mov_b32 v17, v16
  s_nop 1
  v_permlane16_swap_b32 v16, v17
  v_max_f32 v16, v16, v17
  v_mov_b32 v17, v16
  s_nop 1
  v_permlane32_swap_b32 v16, v17
  v_max_f32 v16, v16, v17
  v_sub_f32 v24, v25, v16
  v_mul_f32 v24, 0x3fb8aa3b, v24
  v_exp_f32 v24, v24
  s_waitcnt vmcnt(7)
  s_nop 0
  v_mul_f32_dpp v20, v24, v128 row_newbcast:0 row_mask:0xf bank_mask:0xf
  v_mul_f32_dpp v21, v24, v129 row_newbcast:0 row_mask:0xf bank_mask:0xf
  v_mul_f32 v18, v24, v26
  v_mul_f32_dpp v22, v24, v130 row_newbcast:0 row_mask:0xf bank_mask:0xf
  v_mul_f32_dpp v23, v24, v131 row_newbcast:0 row_mask:0xf bank_mask:0xf
  v_add_f32_dpp v18, v18, v18 row_ror:1 row_mask:0xf bank_mask:0xf
  s_waitcnt vmcnt(6)
  v_fmac_f32_dpp v20, v24, v132 row_newbcast:1 row_mask:0xf bank_mask:0xf
  v_fmac_f32_dpp v21, v24, v133 row_newbcast:1 row_mask:0xf bank_mask:0xf
  v_add_f32_dpp v18, v18, v18 row_ror:2 row_mask:0xf bank_mask:0xf
  v_fmac_f32_dpp v22, v24, v134 row_newbcast:1 row_mask:0xf bank_mask:0xf
  v_fmac_f32_dpp v23, v24, v135 row_newbcast:1 row_mask:0xf bank_mask:0xf
  v_add_f32_dpp v18, v18, v18 row_ror:4 row_mask:0xf bank_mask:0xf
  s_waitcnt vmcnt(5)
  v_fmac_f32_dpp v20, v24, v136 row_newbcast:2 row_mask:0xf bank_mask:0xf
  v_fmac_f32_dpp v21, v24, v137 row_newbcast:2 row_mask:0xf bank_mask:0xf
  v_mov_b32 v19, v18
  v_fmac_f32_dpp v22, v24, v138 row_newbcast:2 row_mask:0xf bank_mask:0xf
  v_fmac_f32_dpp v23, v24, v139 row_newbcast:2 row_mask:0xf bank_mask:0xf
  v_mov_b32 v17, v18
  s_waitcnt vmcnt(4)
  v_fmac_f32_dpp v20, v24, v140 row_newbcast:3 row_mask:0xf bank_mask:0xf
  v_fmac_f32_dpp v21, v24, v141 row_newbcast:3 row_mask:0xf bank_mask:0xf
  v_permlane16_swap_b32 v18, v17
  v_fmac_f32_dpp v22, v24, v142 row_newbcast:3 row_mask:0xf bank_mask:0xf
  v_fmac_f32_dpp v23, v24, v143 row_newbcast:3 row_mask:0xf bank_mask:0xf
  v_add_f32 v18, v18, v17
  s_waitcnt vmcnt(3)
  v_fmac_f32_dpp v20, v24, v144 row_newbcast:4 row_mask:0xf bank_mask:0xf
  v_fmac_f32_dpp v21, v24, v145 row_newbcast:4 row_mask:0xf bank_mask:0xf
  v_mov_b32 v17, v18
  v_fmac_f32_dpp v22, v24, v146 row_newbcast:4 row_mask:0xf bank_mask:0xf
  v_fmac_f32_dpp v23, v24, v147 row_newbcast:4 row_mask:0xf bank_mask:0xf
  v_permlane32_swap_b32 v18, v17
  s_waitcnt vmcnt(2)
  v_fmac_f32_dpp v20, v24, v148 row_newbcast:5 row_mask:0xf bank_mask:0xf
  v_fmac_f32_dpp v21, v24, v149 row_newbcast:5 row_mask:0xf bank_mask:0xf
  v_add_f32 v18, v18, v17
  v_fmac_f32_dpp v22, v24, v150 row_newbcast:5 row_mask:0xf bank_mask:0xf
  v_fmac_f32_dpp v23, v24, v151 row_newbcast:5 row_mask:0xf bank_mask:0xf
  v_rcp_f32 v18, v18
  s_waitcnt vmcnt(1)
  v_fmac_f32_dpp v20, v24, v152 row_newbcast:6 row_mask:0xf bank_mask:0xf
  v_fmac_f32_dpp v21, v24, v153 row_newbcast:6 row_mask:0xf bank_mask:0xf
  v_fmac_f32_dpp v22, v24, v154 row_newbcast:6 row_mask:0xf bank_mask:0xf
  v_fmac_f32_dpp v23, v24, v155 row_newbcast:6 row_mask:0xf bank_mask:0xf
  s_waitcnt vmcnt(0)
  v_fmac_f32_dpp v20, v24, v156 row_newbcast:7 row_mask:0xf bank_mask:0xf
  v_fmac_f32_dpp v21, v24, v157 row_newbcast:7 row_mask:0xf bank_mask:0xf
  v_fmac_f32_dpp v22, v24, v158 row_newbcast:7 row_mask:0xf bank_mask:0xf
  v_fmac_f32_dpp v23, v24, v159 row_newbcast:7 row_mask:0xf bank_mask:0xf
  v_add_f32 v19, v19, v20
  v_add_f32 v17, v21, v22
  v_add_f32 v19, v19, v23
  v_cmp_u_f32 vcc, v19, v17
L_pe1ok45:
  v_permlane32_swap_b32 v20, v22
  v_permlane32_swap_b32 v21, v23
  v_add_f32 v20, v20, v22
  v_add_f32 v21, v21, v23
  s_nop 1
  v_permlane16_swap_b32 v20, v21
  v_add_f32 v20, v20, v21
  v_mul_f32 v20, v20, v18
  s_waitcnt lgkmcnt(0)
  s_nop 0
  v_mov_b32_dpp v21, v20 quad_perm:[1,1,3,3] row_mask:0xf bank_mask:0xf
  v_cvt_pk_bf16_f32 v20, v20, v21
  s_nop 1
  v_mov_b32_dpp v160, v20 row_newbcast:0 row_mask:0xf bank_mask:0xf
  v_mov_b32_dpp v161, v20 row_newbcast:2 row_mask:0xf bank_mask:0xf
  v_mov_b32_dpp v162, v20 row_newbcast:4 row_mask:0xf bank_mask:0xf
  v_mov_b32_dpp v163, v20 row_newbcast:6 row_mask:0xf bank_mask:0xf
  v_mov_b32_dpp v164, v20 row_newbcast:8 row_mask:0xf bank_mask:0xf
  v_mov_b32_dpp v165, v20 row_newbcast:10 row_mask:0xf bank_mask:0xf
  v_mov_b32_dpp v166, v20 row_newbcast:12 row_mask:0xf bank_mask:0xf
  v_mov_b32_dpp v167, v20 row_newbcast:14 row_mask:0xf bank_mask:0xf
  v_mfma_f32_16x16x32_bf16 v[32:35], v[64:67], v[160:163], 0
  v_mfma_f32_16x16x32_bf16 v[36:39], v[72:75], v[160:163], 0
  v_mfma_f32_16x16x32_bf16 v[40:43], v[80:83], v[160:163], 0
  v_mfma_f32_16x16x32_bf16 v[44:47], v[88:91], v[160:163], 0
  v_mfma_f32_16x16x32_bf16 v[32:35], v[68:71], v[164:167], v[32:35]
  v_mfma_f32_16x16x32_bf16 v[36:39], v[76:79], v[164:167], v[36:39]
  v_mfma_f32_16x16x32_bf16 v[40:43], v[84:87], v[164:167], v[40:43]
  v_mfma_f32_16x16x32_bf16 v[44:47], v[92:95], v[164:167], v[44:47]
  s_mov_b32 exec_lo, 0x00010001
  s_mov_b32 exec_hi, 0x00010001
  s_nop 2
  ds_write_b128 v14, v[32:35] offset:0
  ds_write_b128 v14, v[36:39] offset:64
  ds_write_b128 v14, v[40:43] offset:128
  ds_write_b128 v14, v[44:47] offset:192
  s_mov_b64 exec, -1
  s_waitcnt lgkmcnt(0)
  s_barrier
  s_cmp_lt_u32 s52, 1
  s_cbranch_scc0 L_wend
  ds_read_b128 v[32:35], v15 offset:0
  ds_read_b128 v[36:39], v15 offset:256
  ds_read_b128 v[40:43], v15 offset:512
  ds_read_b128 v[44:47], v15 offset:768
  s_waitcnt lgkmcnt(2)
  v_pk_add_f32 v[32:33], v[32:33], v[36:37]
  v_pk_add_f32 v[34:35], v[34:35], v[38:39]
  s_waitcnt lgkmcnt(0)
  v_pk_add_f32 v[40:41], v[40:41], v[44:45]
  v_pk_add_f32 v[42:43], v[42:43], v[46:47]
  v_pk_add_f32 v[32:33], v[32:33], v[40:41]
  v_pk_add_f32 v[34:35], v[34:35], v[42:43]
  v_min_u32 v32, -2, v32
  v_min_u32 v33, -2, v33
  v_min_u32 v34, -2, v34
  v_min_u32 v35, -2, v35
  buffer_store_dwordx4 v[32:35], v13, s[40:43], s73 offen sc1
  s_mov_b64 exec, -1
  s_endpgm
L_ffn:
  s_mov_b32 s48, s4
  s_mov_b32 s49, s5
  s_mov_b32 s50, 0x400
  s_mov_b32 s51, 0x20000
  v_lshrrev_b32 v10, 2, v9
  v_lshl_add_u32 v10, v8, 3, v10
  v_lshlrev_b32 v10, 6, v10
  v_and_b32 v11, 1, v0
  v_lshl_add_u32 v10, v11, 3, v10
  v_and_b32 v11, 2, v0
  v_lshl_add_u32 v10, v11, 14, v10
  v_lshrrev_b32 v11, 1, v11
  v_and_b32 v12, 1, v8
  v_lshl_add_u32 v11, v12, 1, v11
  v_xor_b32 v11, s52, v11
  v_lshl_add_u32 v5, v11, 4, v10
  v_and_b32 v10, 31, v0
  v_lshrrev_b32 v11, 5, v0
  v_lshlrev_b32 v11, 1, v11
  v_lshl_add_u32 v13, v10, 2, v11
  s_lshl_b32 s58, s52, 7
  v_add_u32 v13, s58, v13
  v_lshlrev_b32 v14, 1, v13
  buffer_load_dword v16, v14, s[48:51], 0 offen
  v_add_u32 v14, 70656, v14
  v_lshlrev_b32 v13, 2, v13
  v_lshrrev_b32 v11, 5, v0
  v_lshlrev_b32 v11, 11, v11
  v_lshl_add_u32 v3, v10, 4, v11
  s_lshl_b32 s68, s52, 9
  s_add_u32 s68, s68, 933888
  s_and_b32 s58, s53, 3
  s_lshl_b32 s58, s58, 15
  s_add_u32 s68, s68, s58
  s_and_b32 s58, s64, 15
  s_lshl_b32 s58, s58, 2
  v_and_b32 v10, 3, v0
  v_add_u32 v10, s58, v10
  v_and_b32 v11, 8, v10
  v_lshlrev_b32 v11, 4, v11
  v_lshrrev_b32 v12, 4, v10
  v_lshl_add_u32 v11, v12, 5, v11
  v_and_b32 v12, 7, v10
  v_add_u32 v11, v11, v12
  v_lshl_add_u32 v11, v8, 3, v11
  s_lshr_b32 s58, s64, 4
  s_and_b32 s58, s58, 1
  s_lshl_b32 s58, s58, 8
  v_add_u32 v237, s58, v11
  v_lshrrev_b32 v11, 1, v237
  v_lshlrev_b32 v15, 3, v11
  v_lshlrev_b32 v238, 1, v237
  v_add_u32 v239, 70656, v238
  v_and_b32 v10, 1, v0
  v_lshlrev_b32 v10, 4, v10
  v_mov_b32 v11, 0xffff
  v_lshlrev_b32 v10, v10, v11
  v_lshrrev_b32 v11, 1, v9
  v_cmp_eq_u32 vcc, 0, v11
  s_nop 1
  v_cndmask_b32 v224, 0, v10, vcc
  v_cmp_eq_u32 vcc, 1, v11
  s_nop 1
  v_cndmask_b32 v225, 0, v10, vcc
  v_cmp_eq_u32 vcc, 2, v11
  s_nop 1
  v_cndmask_b32 v226, 0, v10, vcc
  v_cmp_eq_u32 vcc, 3, v11
  s_nop 1
  v_cndmask_b32 v227, 0, v10, vcc
  v_cmp_eq_u32 vcc, 4, v11
  s_nop 1
  v_cndmask_b32 v228, 0, v10, vcc
  v_cmp_eq_u32 vcc, 5, v11
  s_nop 1
  v_cndmask_b32 v229, 0, v10, vcc
  v_cmp_eq_u32 vcc, 6, v11
  s_nop 1
  v_cndmask_b32 v230, 0, v10, vcc
  v_cmp_eq_u32 vcc, 7, v11
  s_nop 1
  v_cndmask_b32 v231, 0, v10, vcc
  s_mov_b32 s69, 8192
  s_mov_b32 s70, 12288
  s_mov_b32 s71, 14336
  v_mov_b32 v40, 90112
  s_mov_b32 s101, 40
  s_mov_b32 s60, 8388608
L_pw48:
  ds_read_b128 v[44:47], v40 offset:32
  s_waitcnt lgkmcnt(0)
  v_add3_u32 v44, v44, v45, v46
  v_add_u32 v44, v44, v47
  v_cmp_gt_u32 vcc, s101, v44
  s_cbranch_vccz L_pd50
  s_sub_u32 s60, s60, 1
  s_cbranch_scc1 L_pd50
  s_sleep 16
  s_branch L_pw48
L_pd50:
L_pwd49:
  s_mov_b32 s60, 524288
L_pf51:
  buffer_load_dwordx2 v[18:19], v13, s[40:43], s69 offen sc1
  buffer_load_dwordx2 v[20:21], v15, s[40:43], s71 offen sc1
  buffer_load_dwordx2 v[22:23], v13, s[40:43], s69 offen offset:2048 sc1
  buffer_load_dwordx2 v[24:25], v13, s[40:43], s70 offen sc1
  s_waitcnt vmcnt(0)
  v_xor_b32 v10, s55, v19
  v_xor_b32 v11, s55, v21
  v_or_b32 v10, v10, v11
  v_xor_b32 v11, s55, v23
  v_or_b32 v10, v10, v11
  v_xor_b32 v11, s55, v25
  v_or_b32 v10, v10, v11
  v_cmp_ne_u32 vcc, 0, v10
  s_cbranch_vccz L_pd52
  s_sub_u32 s60, s60, 1
  s_cbranch_scc1 L_pd52
  s_sleep 8
  s_branch L_pf51
L_pd52:
  v_lshlrev_b32 v232, 16, v16
  v_and_b32 v233, 0xffff0000, v16
  v_lshlrev_b32 v234, 16, v18
  v_and_b32 v235, 0xffff0000, v18
  v_and_b32 v10, 1, v237
  v_cmp_eq_u32 vcc, 0, v10
  v_lshlrev_b32 v10, 16, v20
  v_and_b32 v11, 0xffff0000, v20
  v_cndmask_b32 v236, v11, v10, vcc
  v_lshlrev_b32 v240, 16, v24
  v_and_b32 v241, 0xffff0000, v24
  v_add_f32 v240, 1.0, v240
  v_add_f32 v241, 1.0, v241
  v_cvt_pk_bf16_f32 v12, v240, v241
  v_lshlrev_b32 v240, 16, v12
  v_and_b32 v241, 0xffff0000, v12
  v_subrev_u32 v7, 5120, v14
  ds_write_b32 v7, v12 offset:1024
  ds_write_b32 v7, v22 offset:2048
  v_lshlrev_b32 v6, 4, v8
  v_add_u32 v6, 65536, v6
  v_add_u32 v13, 68608, v2
  s_lshl_b32 s58, s52, 11
  s_add_u32 s58, s58, 81920
  v_add_u32 v15, s58, v2
  s_lshl_b32 s58, s52, 9
  s_add_u32 s58, s58, 81920
  v_add_u32 v4, s58, v2
  s_lshl_b32 s72, s64, 11
  s_lshl_b32 s58, s52, 9
  s_add_u32 s72, s72, s58
  s_add_u32 s72, s72, 819200
  s_add_u32 s73, s68, 4096
  s_add_u32 s74, s68, 8192
  s_add_u32 s75, s68, 12288
  s_add_u32 s76, s68, 16384
  s_add_u32 s77, s68, 20480
  s_add_u32 s78, s68, 24576
  s_add_u32 s79, s68, 28672
  s_waitcnt lgkmcnt(0)
  s_branch L_bal
L_ffnb:
  s_mov_b32 s61, 0x3f803f80
  s_mov_b32 s59, 0xbfb8aa3b
  v_mov_b32 v28, 0x3b000000
  v_mov_b32 v29, 0x3727c5ac
  s_lshl_b32 s58, s52, 2
  v_add_u32 v30, s58, v13
  s_mul_i32 s64, s53, 7
  s_add_u32 s64, s64, s54
  s_sub_u32 s64, s64, 16
  s_and_b32 s58, s52, 1
  s_cselect_b64 s[44:45], s[18:19], s[16:17]
  s_mov_b32 s46, 1835008
  s_mov_b32 s47, 0x20000
  s_lshl_b32 s67, s58, 15
  s_lshr_b32 s58, s52, 1
  s_lshl_b32 s59, s58, 10
  s_add_u32 s67, s67, s59
  s_mul_i32 s66, s58, 57344
  s_lshl_b32 s58, s64, 6
  s_add_u32 s66, s66, s58
  v_lshrrev_b32 v31, 2, v0
  s_mov_b32 s59, 3584
  v_mul_lo_u32 v31, v31, s59
  v_lshrrev_b32 v10, 4, v0
  v_and_b32 v10, 2, v10
  v_xor_b32 v10, v10, v0
  s_and_b32 s58, s52, 1
  v_xor_b32 v10, s58, v10
  v_and_b32 v10, 3, v10
  v_lshl_add_u32 v31, v10, 4, v31
  s_add_u32 m0, s67, 12288
  s_add_u32 s59, s66, 688128
  buffer_load_dwordx4 v31, s[44:47], s59 offen lds
  s_add_u32 m0, s67, 14336
  s_add_u32 s59, s66, 802816
  buffer_load_dwordx4 v31, s[44:47], s59 offen lds
  s_add_u32 m0, s67, 16384
  s_add_u32 s59, s66, 917504
  buffer_load_dwordx4 v31, s[44:47], s59 offen lds
  s_add_u32 m0, s67, 18432
  s_add_u32 s59, s66, 1032192
  buffer_load_dwordx4 v31, s[44:47], s59 offen lds
  s_barrier
  s_barrier
  s_mul_i32 s64, s53, 7
  s_add_u32 s64, s64, s54
  s_sub_u32 s64, s64, 16
  s_and_b32 s58, s52, 1
  s_cselect_b64 s[44:45], s[18:19], s[16:17]
  s_mov_b32 s46, 1835008
  s_mov_b32 s47, 0x20000
  s_lshl_b32 s67, s58, 15
  s_lshr_b32 s58, s52, 1
  s_lshl_b32 s59, s58, 10
  s_add_u32 s67, s67, s59
  s_mul_i32 s66, s58, 57344
  s_lshl_b32 s58, s64, 6
  s_add_u32 s66, s66, s58
  v_lshrrev_b32 v31, 2, v0
  s_mov_b32 s59, 3584
  v_mul_lo_u32 v31, v31, s59
  v_lshrrev_b32 v10, 4, v0
  v_and_b32 v10, 2, v10
  v_xor_b32 v10, v10, v0
  s_and_b32 s58, s52, 1
  v_xor_b32 v10, s58, v10
  v_and_b32 v10, 3, v10
  v_lshl_add_u32 v31, v10, 4, v31
  s_add_u32 m0, s67, 20480
  s_add_u32 s59, s66, 1146880
  buffer_load_dwordx4 v31, s[44:47], s59 offen lds
  s_add_u32 m0, s67, 22528
  s_add_u32 s59, s66, 1261568
  buffer_load_dwordx4 v31, s[44:47], s59 offen lds
  s_add_u32 m0, s67, 24576
  s_add_u32 s59, s66, 1376256
  buffer_load_dwordx4 v31, s[44:47], s59 offen lds
  s_add_u32 m0, s67, 26624
  s_add_u32 s59, s66, 1490944
  buffer_load_dwordx4 v31, s[44:47], s59 offen lds
  s_add_u32 m0, s67, 28672
  s_add_u32 s59, s66, 1605632
  buffer_load_dwordx4 v31, s[44:47], s59 offen lds
  s_add_u32 m0, s67, 30720
  s_add_u32 s59, s66, 1720320
  buffer_load_dwordx4 v31, s[44:47], s59 offen lds
  s_mov_b32 s44, s20
  s_mov_b32 s45, s21
  s_mov_b32 s46, 0x1c0000
  s_mov_b32 s47, 0x20000
  v_and_b32 v10, 1, v8
  v_lshlrev_b32 v10, 12, v10
  v_lshrrev_b32 v11, 1, v8
  v_lshl_add_u32 v10, v11, 11, v10
  v_lshl_add_u32 v31, v9, 4, v10
  s_lshl_b32 s66, s64, 2
  s_add_u32 s66, s66, s52
  s_lshl_b32 s66, s66, 13
  buffer_load_dwordx4 v[128:131], v31, s[44:47], s66 offen offset:0 nt
  buffer_load_dwordx4 v[132:135], v31, s[44:47], s66 offen offset:256 nt
  buffer_load_dwordx4 v[136:139], v31, s[44:47], s66 offen offset:512 nt
  buffer_load_dwordx4 v[140:143], v31, s[44:47], s66 offen offset:768 nt
  buffer_load_dwordx4 v[144:147], v31, s[44:47], s66 offen offset:1024 nt
  buffer_load_dwordx4 v[148:151], v31, s[44:47], s66 offen offset:1280 nt
  buffer_load_dwordx4 v[152:155], v31, s[44:47], s66 offen offset:1536 nt
  buffer_load_dwordx4 v[156:159], v31, s[44:47], s66 offen offset:1792 nt
  s_waitcnt vmcnt(8)
  s_barrier
  ds_read_b64_tr_b16 v[88:89], v5 offset:12288
  ds_read_b64_tr_b16 v[90:91], v5 offset:12544
  ds_read_b64_tr_b16 v[92:93], v5 offset:14336
  ds_read_b64_tr_b16 v[94:95], v5 offset:14592
  ds_read_b64_tr_b16 v[96:97], v5 offset:16384
  ds_read_b64_tr_b16 v[98:99], v5 offset:16640
  ds_read_b64_tr_b16 v[100:101], v5 offset:18432
  ds_read_b64_tr_b16 v[102:103], v5 offset:18688
  ds_read_b64_tr_b16 v[104:105], v5 offset:20480
  ds_read_b64_tr_b16 v[106:107], v5 offset:20736
  ds_read_b64_tr_b16 v[108:109], v5 offset:22528
  ds_read_b64_tr_b16 v[110:111], v5 offset:22784
  ds_read_b64_tr_b16 v[112:113], v5 offset:24576
  ds_read_b64_tr_b16 v[114:115], v5 offset:24832
  ds_read_b64_tr_b16 v[116:117], v5 offset:26624
  ds_read_b64_tr_b16 v[118:119], v5 offset:26880
  ds_read_b64_tr_b16 v[120:121], v5 offset:28672
  ds_read_b64_tr_b16 v[122:123], v5 offset:28928
  ds_read_b64_tr_b16 v[124:125], v5 offset:30720
  ds_read_b64_tr_b16 v[126:127], v5 offset:30976
  s_waitcnt lgkmcnt(15)
  v_mfma_f32_16x16x32_bf16 v[52:55], v[88:91], v[184:187], v[52:55]
  s_waitcnt lgkmcnt(15)
  v_mfma_f32_16x16x32_bf16 v[52:55], v[92:95], v[188:191], v[52:55]
  s_waitcnt lgkmcnt(14)
  v_mfma_f32_16x16x32_bf16 v[52:55], v[96:99], v[192:195], v[52:55]
  s_waitcnt lgkmcnt(12)
  v_mfma_f32_16x16x32_bf16 v[52:55], v[100:103], v[196:199], v[52:55]
  s_waitcnt lgkmcnt(10)
  v_mfma_f32_16x16x32_bf16 v[52:55], v[104:107], v[200:203], v[52:55]
  s_waitcnt lgkmcnt(8)
  v_mfma_f32_16x16x32_bf16 v[52:55], v[108:111], v[204:207], v[52:55]
  s_waitcnt lgkmcnt(6)
  v_mfma_f32_16x16x32_bf16 v[52:55], v[112:115], v[208:211], v[52:55]
  s_waitcnt lgkmcnt(4)
  v_mfma_f32_16x16x32_bf16 v[52:55], v[116:119], v[212:215], v[52:55]
  s_waitcnt lgkmcnt(2)
  v_mfma_f32_16x16x32_bf16 v[52:55], v[120:123], v[216:219], v[52:55]
  s_waitcnt lgkmcnt(0)
  v_mfma_f32_16x16x32_bf16 v[52:55], v[124:127], v[220:223], v[52:55]
  s_nop 7
  v_permlane32_swap_b32 v52, v54
  v_permlane32_swap_b32 v53, v55
  s_nop 0
  v_mov_b32_dpp v244, v52 quad_perm:[0,0,2,2] row_mask:0xf bank_mask:0xf
  v_mov_b32_dpp v248, v52 quad_perm:[1,1,3,3] row_mask:0xf bank_mask:0xf
  v_mov_b32_dpp v245, v53 quad_perm:[0,0,2,2] row_mask:0xf bank_mask:0xf
  v_mov_b32_dpp v249, v53 quad_perm:[1,1,3,3] row_mask:0xf bank_mask:0xf
  v_mov_b32_dpp v246, v54 quad_perm:[0,0,2,2] row_mask:0xf bank_mask:0xf
  v_mov_b32_dpp v250, v54 quad_perm:[1,1,3,3] row_mask:0xf bank_mask:0xf
  v_mov_b32_dpp v247, v55 quad_perm:[0,0,2,2] row_mask:0xf bank_mask:0xf
  v_mov_b32_dpp v251, v55 quad_perm:[1,1,3,3] row_mask:0xf bank_mask:0xf
  s_mov_b32 s59, 0xbfb8aa3b
  s_mov_b32 s44, s30
  s_mov_b32 s45, s31
  s_mov_b32 s46, 0xe4000
  s_mov_b32 s47, 0x20000
  s_mov_b32 s48, s26
  s_mov_b32 s49, s27
  s_mov_b32 s50, 0x400
  s_mov_b32 s51, 0x20000
  v_lshrrev_b32 v5, 2, v0
  v_lshlrev_b32 v5, 11, v5
  v_and_b32 v10, 3, v0
  v_lshl_add_u32 v5, v10, 4, v5
  s_and_b32 s65, s64, 31
  s_lshl_b32 s65, s65, 6
  s_add_u32 s65, s65, 819200
  s_add_u32 s66, s65, 32768
  s_add_u32 s67, s65, 65536
  s_add_u32 s69, s65, 98304
  s_mov_b32 s60, 524288
L_pe253:
  buffer_load_dwordx4 v[192:195], v3, s[40:43], s68 offen sc1
  buffer_load_dwordx4 v[196:199], v3, s[40:43], s73 offen sc1
  buffer_load_dwordx4 v[200:203], v3, s[40:43], s74 offen sc1
  buffer_load_dwordx4 v[204:207], v3, s[40:43], s75 offen sc1
  buffer_load_dwordx4 v[208:211], v3, s[40:43], s76 offen sc1
  buffer_load_dwordx4 v[212:215], v3, s[40:43], s77 offen sc1
  buffer_load_dwordx4 v[216:219], v3, s[40:43], s78 offen sc1
  buffer_load_dwordx4 v[220:223], v3, s[40:43], s79 offen sc1
  s_mov_b64 exec, -1
L_pe2sl55:
  s_waitcnt vmcnt(6)
  v_pk_add_f32 v[20:21], v[192:193], v[196:197]
  v_pk_add_f32 v[22:23], v[194:195], v[198:199]
  s_waitcnt vmcnt(5)
  v_pk_add_f32 v[20:21], v[20:21], v[200:201]
  v_pk_add_f32 v[22:23], v[22:23], v[202:203]
  s_waitcnt vmcnt(4)
  v_pk_add_f32 v[20:21], v[20:21], v[204:205]
  v_pk_add_f32 v[22:23], v[22:23], v[206:207]
  s_waitcnt vmcnt(3)
  v_pk_add_f32 v[20:21], v[20:21], v[208:209]
  v_pk_add_f32 v[22:23], v[22:23], v[210:211]
  s_waitcnt vmcnt(2)
  v_pk_add_f32 v[20:21], v[20:21], v[212:213]
  v_pk_add_f32 v[22:23], v[22:23], v[214:215]
  s_waitcnt vmcnt(1)
  v_pk_add_f32 v[20:21], v[20:21], v[216:217]
  v_pk_add_f32 v[22:23], v[22:23], v[218:219]
  s_waitcnt vmcnt(0)
  v_pk_add_f32 v[20:21], v[20:21], v[220:221]
  v_pk_add_f32 v[22:23], v[22:23], v[222:223]
  v_pk_add_f32 v[10:11], v[20:21], v[22:23]
  v_cmp_u_f32 vcc, v10, v11
  s_cbranch_vccz L_pe2ok54
  s_sub_u32 s60, s60, 1
  s_and_b32 s58, s60, 63
  s_mov_b64 exec, vcc
  s_cbranch_scc1 L_pe253
  s_mov_b64 exec, -1
  s_waitcnt vmcnt(0)
  v_max_u32 v10, v192, v193
  v_max3_u32 v10, v10, v194, v195
  v_max3_u32 v10, v10, v196, v197
  v_max3_u32 v10, v10, v198, v199
  v_max3_u32 v10, v10, v200, v201
  v_max3_u32 v10, v10, v202, v203
  v_max3_u32 v10, v10, v204, v205
  v_max3_u32 v10, v10, v206, v207
  v_max3_u32 v10, v10, v208, v209
  v_max3_u32 v10, v10, v210, v211
  v_max3_u32 v10, v10, v212, v213
  v_max3_u32 v10, v10, v214, v215
  v_max3_u32 v10, v10, v216, v217
  v_max3_u32 v10, v10, v218, v219
  v_max3_u32 v10, v10, v220, v221
  v_max3_u32 v10, v10, v222, v223
  v_cmp_eq_u32 vcc, -1, v10
  s_cbranch_vccz L_pe2fin56
  s_cmp_eq_u32 s60, 0
  s_cbranch_scc0 L_pe253
L_pe2fin56:
  s_waitcnt vmcnt(6)
  v_pk_add_f32 v[20:21], v[192:193], v[196:197]
  v_pk_add_f32 v[22:23], v[194:195], v[198:199]
  s_waitcnt vmcnt(5)
  v_pk_add_f32 v[20:21], v[20:21], v[200:201]
  v_pk_add_f32 v[22:23], v[22:23], v[202:203]
  s_waitcnt vmcnt(4)
  v_pk_add_f32 v[20:21], v[20:21], v[204:205]
  v_pk_add_f32 v[22:23], v[22:23], v[206:207]
  s_waitcnt vmcnt(3)
  v_pk_add_f32 v[20:21], v[20:21], v[208:209]
  v_pk_add_f32 v[22:23], v[22:23], v[210:211]
  s_waitcnt vmcnt(2)
  v_pk_add_f32 v[20:21], v[20:21], v[212:213]
  v_pk_add_f32 v[22:23], v[22:23], v[214:215]
  s_waitcnt vmcnt(1)
  v_pk_add_f32 v[20:21], v[20:21], v[216:217]
  v_pk_add_f32 v[22:23], v[22:23], v[218:219]
  s_waitcnt vmcnt(0)
  v_pk_add_f32 v[20:21], v[20:21], v[220:221]
  v_pk_add_f32 v[22:23], v[22:23], v[222:223]
  v_pk_add_f32 v[10:11], v[20:21], v[22:23]
  v_cmp_u_f32 vcc, v10, v11
L_pe2ok54:
  v_permlane32_swap_b32 v20, v22
  v_permlane32_swap_b32 v21, v23
  v_add_f32 v20, v20, v22
  v_add_f32 v21, v21, v23
  v_fma_f32 v20, v20, v234, v232
  v_fma_f32 v21, v21, v235, v233
  v_mul_f32 v11, v20, v20
  v_add_f32 v10, v20, v21
  v_fmac_f32 v11, v21, v21
  v_mul_f32 v22, v20, v240
  v_mul_f32 v23, v21, v241
  v_permlane32_swap_b32 v10, v11
  v_cvt_pk_bf16_f32 v12, v20, v21
  v_cvt_pk_bf16_f32 v20, v22, v23
  v_add_f32 v10, v10, v11
  ds_write_b32 v30, v10
  ds_write_b32 v14, v12
  ds_write_b32 v7, v20
  s_waitcnt lgkmcnt(0)
  s_barrier
  ds_read_b128 v[24:27], v13
  ds_read_b128 v[160:163], v6 offset:0
  ds_read_b128 v[164:167], v6 offset:64
  ds_read_b128 v[168:171], v6 offset:128
  ds_read_b128 v[172:175], v6 offset:192
  ds_read_b128 v[176:179], v6 offset:256
  s_waitcnt lgkmcnt(4)
  v_mfma_f32_16x16x32_bf16 v[16:19], v[64:67], v[160:163], 0
  ds_read_b128 v[180:183], v6 offset:320
  v_add_f32 v10, v24, v25
  v_add_f32 v11, v26, v27
  s_waitcnt lgkmcnt(3)
  v_mfma_f32_16x16x32_bf16 v[16:19], v[68:71], v[164:167], v[16:19]
  ds_read_b128 v[184:187], v6 offset:384
  v_add_f32 v10, v10, v11
  v_mov_b32 v11, v10
  v_mfma_f32_16x16x32_bf16 v[16:19], v[72:75], v[168:171], v[16:19]
  ds_read_b128 v[188:191], v6 offset:448
  v_permlane16_swap_b32 v10, v11
  v_add_f32 v10, v10, v11
  s_waitcnt lgkmcnt(3)
  v_mfma_f32_16x16x32_bf16 v[16:19], v[76:79], v[172:175], v[16:19]
  ds_read_b128 v[160:163], v6 offset:512
  v_add_f32_dpp v10, v10, v10 row_ror:8 row_mask:0xf bank_mask:0xf
  s_nop 1
  v_add_f32_dpp v10, v10, v10 row_ror:4 row_mask:0xf bank_mask:0xf
  v_mfma_f32_16x16x32_bf16 v[16:19], v[80:83], v[176:179], v[16:19]
  ds_read_b128 v[164:167], v6 offset:576
  v_add_f32_dpp v10, v10, v10 quad_perm:[1,0,3,2] row_mask:0xf bank_mask:0xf
  s_nop 1
  v_add_f32_dpp v10, v10, v10 quad_perm:[2,3,0,1] row_mask:0xf bank_mask:0xf
  s_waitcnt lgkmcnt(3)
  v_mfma_f32_16x16x32_bf16 v[16:19], v[84:87], v[180:183], v[16:19]
  ds_read_b128 v[168:171], v6 offset:640
  v_readlane_b32 s62, v10, 0
  v_readlane_b32 s63, v10, 32
  v_mfma_f32_16x16x32_bf16 v[16:19], v[88:91], v[184:187], v[16:19]
  ds_read_b128 v[172:175], v6 offset:704
  v_mul_f32 v10, s62, v28
  v_fma_f32 v11, s63, v28, v29
  s_waitcnt lgkmcnt(3)
  v_mfma_f32_16x16x32_bf16 v[16:19], v[92:95], v[188:191], v[16:19]
  ds_read_b128 v[176:179], v6 offset:768
  v_fma_f32 v11, -v10, v10, v11
  v_max_f32 v11, v11, v29
  v_mfma_f32_16x16x32_bf16 v[16:19], v[96:99], v[160:163], v[16:19]
  ds_read_b128 v[180:183], v6 offset:832
  v_rsq_f32 v11, v11
  s_nop 0
  v_mul_f32 v10, v10, v11
  s_waitcnt lgkmcnt(3)
  v_mfma_f32_16x16x32_bf16 v[16:19], v[100:103], v[164:167], v[16:19]
  ds_read_b128 v[184:187], v6 offset:896
  v_fma_f32 v248, -v10, v244, v248
  v_fma_f32 v249, -v10, v245, v249
  v_mfma_f32_16x16x32_bf16 v[16:19], v[104:107], v[168:171], v[16:19]
  ds_read_b128 v[188:191], v6 offset:960
  v_fma_f32 v250, -v10, v246, v250
  v_fma_f32 v251, -v10, v247, v251
  s_waitcnt lgkmcnt(3)
  v_mfma_f32_16x16x32_bf16 v[16:19], v[108:111], v[172:175], v[16:19]
  v_mfma_f32_16x16x32_bf16 v[16:19], v[112:115], v[176:179], v[16:19]
  s_waitcnt lgkmcnt(1)
  v_mfma_f32_16x16x32_bf16 v[16:19], v[116:119], v[180:183], v[16:19]
  v_mfma_f32_16x16x32_bf16 v[16:19], v[120:123], v[184:187], v[16:19]
  s_waitcnt lgkmcnt(0)
  v_mfma_f32_16x16x32_bf16 v[16:19], v[124:127], v[188:191], v[16:19]
  ds_read_u16 v63, v239
  s_nop 6
  v_permlane32_swap_b32 v16, v18
  v_permlane32_swap_b32 v17, v19
  v_fma_f32 v16, v16, v11, v248
  v_fma_f32 v17, v17, v11, v249
  v_fma_f32 v18, v18, v11, v250
  v_fma_f32 v19, v19, v11, v251
  v_mul_f32 v20, s59, v16
  v_mul_f32 v21, s59, v17
  v_exp_f32 v20, v20
  v_exp_f32 v21, v21
  v_mul_f32 v16, v16, v18
  v_mul_f32 v17, v17, v19
  v_add_f32 v20, 1.0, v20
  v_add_f32 v21, 1.0, v21
  v_rcp_f32 v20, v20
  v_rcp_f32 v21, v21
  v_mul_f32 v16, v16, v20
  v_mul_f32 v17, v17, v21
  v_cvt_pk_bf16_f32 v16, v16, v16
  v_cvt_pk_bf16_f32 v17, v17, v17
  s_nop 0
  v_and_b32_dpp v32, v16, v224 row_newbcast:0 row_mask:0xf bank_mask:0xf
  v_and_b32_dpp v33, v16, v225 row_newbcast:0 row_mask:0xf bank_mask:0xf
  v_and_b32_dpp v34, v16, v226 row_newbcast:0 row_mask:0xf bank_mask:0xf
  v_and_b32_dpp v35, v16, v227 row_newbcast:0 row_mask:0xf bank_mask:0xf
  v_and_b32_dpp v36, v16, v228 row_newbcast:0 row_mask:0xf bank_mask:0xf
  v_and_b32_dpp v37, v16, v229 row_newbcast:0 row_mask:0xf bank_mask:0xf
  v_and_b32_dpp v38, v16, v230 row_newbcast:0 row_mask:0xf bank_mask:0xf
  v_and_b32_dpp v39, v16, v231 row_newbcast:0 row_mask:0xf bank_mask:0xf
  v_mfma_f32_16x16x32_bf16 v[24:27], v[128:131], v[32:35], 0
  v_mfma_f32_16x16x32_bf16 v[28:31], v[136:139], v[32:35], 0
  v_and_b32_dpp v40, v17, v224 row_newbcast:0 row_mask:0xf bank_mask:0xf
  v_and_b32_dpp v41, v17, v225 row_newbcast:0 row_mask:0xf bank_mask:0xf
  v_and_b32_dpp v42, v17, v226 row_newbcast:0 row_mask:0xf bank_mask:0xf
  v_and_b32_dpp v43, v17, v227 row_newbcast:0 row_mask:0xf bank_mask:0xf
  v_mfma_f32_16x16x32_bf16 v[24:27], v[132:135], v[36:39], v[24:27]
  v_mfma_f32_16x16x32_bf16 v[28:31], v[140:143], v[36:39], v[28:31]
  v_and_b32_dpp v44, v17, v228 row_newbcast:0 row_mask:0xf bank_mask:0xf
  v_and_b32_dpp v45, v17, v229 row_newbcast:0 row_mask:0xf bank_mask:0xf
  v_and_b32_dpp v46, v17, v230 row_newbcast:0 row_mask:0xf bank_mask:0xf
  v_and_b32_dpp v47, v17, v231 row_newbcast:0 row_mask:0xf bank_mask:0xf
  v_mfma_f32_16x16x32_bf16 v[24:27], v[144:147], v[40:43], v[24:27]
  v_mfma_f32_16x16x32_bf16 v[28:31], v[152:155], v[40:43], v[28:31]
  v_mfma_f32_16x16x32_bf16 v[24:27], v[148:151], v[44:47], v[24:27]
  v_mfma_f32_16x16x32_bf16 v[28:31], v[156:159], v[44:47], v[28:31]
  s_nop 6
  ds_write_b128 v15, v[24:27]
  ds_write_b128 v15, v[28:31] offset:1024
  s_waitcnt lgkmcnt(0)
  s_barrier
  s_mov_b32 exec_hi, 0
  ds_read_b128 v[32:35], v4 offset:0
  ds_read_b128 v[36:39], v4 offset:2048
  ds_read_b128 v[40:43], v4 offset:4096
  ds_read_b128 v[44:47], v4 offset:6144
  s_waitcnt lgkmcnt(2)
  v_pk_add_f32 v[32:33], v[32:33], v[36:37]
  v_pk_add_f32 v[34:35], v[34:35], v[38:39]
  s_waitcnt lgkmcnt(0)
  v_pk_add_f32 v[40:41], v[40:41], v[44:45]
  v_pk_add_f32 v[42:43], v[42:43], v[46:47]
  v_pk_add_f32 v[32:33], v[32:33], v[40:41]
  v_pk_add_f32 v[34:35], v[34:35], v[42:43]
  v_min_u32 v32, -2, v32
  v_min_u32 v33, -2, v33
  v_min_u32 v34, -2, v34
  v_min_u32 v35, -2, v35
  buffer_store_dwordx4 v[32:35], v2, s[40:43], s72 offen sc1
  s_mov_b64 exec, -1
  s_cmp_eq_u32 s52, 0
  s_cbranch_scc0 L_wend
  s_cmp_lt_u32 s64, 32
  s_cbranch_scc0 L_wend
  v_lshlrev_b32 v63, 16, v63
  s_waitcnt vmcnt(0)
  s_mov_b32 s60, 524288
L_pe357:
  buffer_load_dwordx4 v[160:163], v5, s[44:47], s65 offen sc1
  buffer_load_dwordx4 v[164:167], v5, s[44:47], s66 offen sc1
  buffer_load_dwordx4 v[168:171], v5, s[44:47], s67 offen sc1
  buffer_load_dwordx4 v[172:175], v5, s[44:47], s69 offen sc1
  s_mov_b64 exec, -1
L_pe3sl59:
  s_waitcnt vmcnt(2)
  v_pk_add_f32 v[20:21], v[160:161], v[164:165]
  v_pk_add_f32 v[22:23], v[162:163], v[166:167]
  s_waitcnt vmcnt(0)
  v_pk_add_f32 v[24:25], v[168:169], v[172:173]
  v_pk_add_f32 v[26:27], v[170:171], v[174:175]
  v_pk_add_f32 v[20:21], v[20:21], v[24:25]
  v_pk_add_f32 v[22:23], v[22:23], v[26:27]
  v_pk_add_f32 v[10:11], v[20:21], v[22:23]
  v_cmp_u_f32 vcc, v10, v11
  s_cbranch_vccz L_pe3ok58
  s_sub_u32 s60, s60, 1
  s_and_b32 s58, s60, 63
  s_mov_b64 exec, vcc
  s_cbranch_scc1 L_pe357
  s_mov_b64 exec, -1
  s_waitcnt vmcnt(0)
  v_max_u32 v10, v160, v161
  v_max3_u32 v10, v10, v162, v163
  v_max3_u32 v10, v10, v164, v165
  v_max3_u32 v10, v10, v166, v167
  v_max3_u32 v10, v10, v168, v169
  v_max3_u32 v10, v10, v170, v171
  v_max3_u32 v10, v10, v172, v173
  v_max3_u32 v10, v10, v174, v175
  v_cmp_eq_u32 vcc, -1, v10
  s_cbranch_vccz L_pe3fin60
  s_cmp_eq_u32 s60, 0
  s_cbranch_scc0 L_pe357
L_pe3fin60:
  s_waitcnt vmcnt(2)
  v_pk_add_f32 v[20:21], v[160:161], v[164:165]
  v_pk_add_f32 v[22:23], v[162:163], v[166:167]
  s_waitcnt vmcnt(0)
  v_pk_add_f32 v[24:25], v[168:169], v[172:173]
  v_pk_add_f32 v[26:27], v[170:171], v[174:175]
  v_pk_add_f32 v[20:21], v[20:21], v[24:25]
  v_pk_add_f32 v[22:23], v[22:23], v[26:27]
  v_pk_add_f32 v[10:11], v[20:21], v[22:23]
  v_cmp_u_f32 vcc, v10, v11
L_pe3ok58:
  v_permlane32_swap_b32 v20, v22
  v_permlane32_swap_b32 v21, v23
  v_add_f32 v20, v20, v22
  v_add_f32 v21, v21, v23
  s_nop 1
  v_permlane16_swap_b32 v20, v21
  v_add_f32 v20, v20, v21
  s_nop 1
  v_add_f32_dpp v20, v20, v20 row_ror:8 row_mask:0xf bank_mask:0xf
  s_nop 1
  v_add_f32_dpp v20, v20, v20 row_ror:4 row_mask:0xf bank_mask:0xf
  v_cvt_pk_bf16_f32 v20, v20, v20
  v_and_b32 v20, 0xffff0000, v20
  v_mul_f32 v20, v20, v236
  v_cvt_pk_bf16_f32 v20, v20, v20
  v_and_b32 v20, 0xffff0000, v20
  v_add_f32 v20, v20, v63
  v_cvt_pk_bf16_f32 v20, v20, v20
  s_mov_b32 exec_lo, 0x000f000f
  s_mov_b32 exec_hi, 0x000f000f
  buffer_store_short v20, v238, s[48:51], 0 offen
  s_mov_b64 exec, -1
  s_cmp_eq_u32 s64, 0
  s_cbranch_scc0 L_wend
  v_mov_b32 v10, s55
  v_mov_b32 v11, 0
  s_mov_b64 exec, 1
  buffer_store_dword v10, v11, s[40:43], 0 offen offset:0
  s_mov_b64 exec, -1
  s_endpgm
L_exit:
  s_endpgm
L_codeend:
.section .rodata,"a"
.p2align 6
.amdhsa_kernel adaLN_cond__gqa_block_cached__swiglu_ffn__decode_kernel
  .amdhsa_next_free_vgpr 256
  .amdhsa_next_free_sgpr 102
  .amdhsa_accum_offset 256
  .amdhsa_group_segment_fixed_size 0
  .amdhsa_kernarg_size 112
  .amdhsa_user_sgpr_count 2
  .amdhsa_user_sgpr_kernarg_segment_ptr 1
  .amdhsa_system_sgpr_workgroup_id_x 1
.end_amdhsa_kernel
```
